```python
import torch

def _softmax(x, axis=-1):
    return torch.softmax(x, dim=axis)
def _gelu(x):
    return torch.nn.functional.gelu(x, approximate="tanh")
def _silu(x):
    return torch.nn.functional.silu(x)
def _sigmoid(x):
    return torch.sigmoid(x)
def _layernorm(x, axis=-1, eps=1e-5):
    m = x.mean(dim=axis, keepdim=True)
    v = x.var(dim=axis, keepdim=True, unbiased=False)
    return (x - m) / torch.sqrt(v + eps)
def _scatter_add(tgt, idx, src, axis=0):
    return tgt.clone().index_add_(axis, idx, src)
def _segment_sum(src, seg, n):
    out = torch.zeros((n,) + src.shape[1:], dtype=src.dtype)
    return out.index_add_(0, seg, src)
def _pad(x, pw):
    flat = tuple(v for pair in reversed(pw) for v in pair)
    return torch.nn.functional.pad(x, flat)

kernel_name = 'gated_mix__ssm_conv_s4__glu_gated_bilinear__prompt'

def setup_inputs():

    _w = (lambda a: (lambda t: t.to(torch.bfloat16) if t.is_floating_point() else t)(torch.as_tensor(a)))
    def _A_setup():
        B, L, D, N = 1, 2048, 640, 192
        A_re = -(lambda _x: torch.exp(torch.as_tensor(_x)))((lambda *s: torch.randn(*s, dtype=torch.bfloat16) * 6.4)(D, N))
        A_im = torch.pi * (lambda *s: torch.randn(*s, dtype=torch.bfloat16) * 0.05)(D, N)
        B_re = (lambda *s: torch.randn(*s, dtype=torch.bfloat16) * 0.05)(D, N)
        B_im = (lambda *s: torch.randn(*s, dtype=torch.bfloat16) * 0.05)(D, N)
        C_re = (lambda *s: torch.randn(*s, dtype=torch.bfloat16) * 0.05)(D, N)
        C_im = (lambda *s: torch.randn(*s, dtype=torch.bfloat16) * 0.05)(D, N)
        log_dt = (lambda *s: torch.randn(*s, dtype=torch.bfloat16) * 0.05)(D) * 0.5 - 4.0
        Dskip = (lambda *s: torch.randn(*s, dtype=torch.bfloat16) * 0.05)(D)
        return {
            "u": _w((lambda *s: torch.randn(*s, dtype=torch.bfloat16) * 0.05)(B, L, D)),
            "A_re": _w(A_re),
            "A_im": _w(A_im),
            "B_re": _w(B_re),
            "B_im": _w(B_im),
            "C_re": _w(C_re),
            "C_im": _w(C_im),
            "log_dt": _w(log_dt),
            "Dskip": _w(Dskip),
        }
    _A_in = _A_setup()

    def _B_setup():
        B, S, D, F = 1, 2048, 640, 1536
        return {
            "x": _w((lambda *s: torch.randn(*s, dtype=torch.bfloat16) * 0.05)(B, S, D)),
            "w_gate": _w((lambda *s: torch.randn(*s, dtype=torch.bfloat16) * 0.8)(D, F) * (D ** -0.5)),
            "w_up": _w((lambda *s: torch.randn(*s, dtype=torch.bfloat16) * 0.8)(D, F) * (D ** -0.5)),
            "w_down": _w((lambda *s: torch.randn(*s, dtype=torch.bfloat16) * 0.8)(F, D) * (F ** -0.5)),
        }
    _B_in = _B_setup()

    return {
        "A_u": _A_in["u"],
        "A_A_re": _A_in["A_re"],
        "A_A_im": _A_in["A_im"],
        "A_B_re": _A_in["B_re"],
        "A_B_im": _A_in["B_im"],
        "A_C_re": _A_in["C_re"],
        "A_C_im": _A_in["C_im"],
        "A_log_dt": _A_in["log_dt"],
        "A_Dskip": _A_in["Dskip"],
        "B_x": _B_in["x"],
        "B_w_gate": _B_in["w_gate"],
        "B_w_up": _B_in["w_up"],
        "B_w_down": _B_in["w_down"],
        "gate_w": _w((lambda *s: torch.randn(*s, dtype=torch.bfloat16) * 0.05)(640) * 16.0),
    }

def reference(A_u, A_A_re, A_A_im, A_B_re, A_B_im, A_C_re, A_C_im, A_log_dt, A_Dskip, B_x, B_w_gate, B_w_up, B_w_down, gate_w):
    def _A_ref(u, A_re, A_im, B_re, B_im, C_re, C_im, log_dt, Dskip):
        Bsz, L, D = u.shape
        dt = torch.exp(log_dt)[:, None]
        A = A_re + 1j * A_im
        Bc = B_re + 1j * B_im
        Cc = C_re + 1j * C_im
        logdA = dt * A
        dB = dt * Bc
        l = (lambda x, dt: x.to(dt))(torch.arange(L), A_re.dtype)
        P = torch.exp(logdA[:, :, None] * l[None, None, :])
        K = torch.einsum("dn,dnl,dn->dl", Cc, P, dB).real
        L2 = 2 * L
        Kp = _pad(K, ((0, 0), (0, L)))
        up = (lambda x, *d: x.permute(*d))(u, 0, 2, 1)
        up = _pad(up, ((0, 0), (0, 0), (0, L)))
        Kf = (lambda x, axes=(-2,-1): torch.fft.rfft2(x.float(), dim=axes))(Kp[:, None, :], axes=(-2, -1))
        Uf = (lambda x, axes=(-2,-1): torch.fft.rfft2(x.float(), dim=axes))(up[:, :, None, :], axes=(-2, -1))
        Yf = Uf * Kf[None, :, :, :]
        y = (lambda x, s, axes=(-2,-1): torch.fft.irfft2(x, s=s, dim=axes).to(torch.bfloat16))(Yf, (1, L2), axes=(-2, -1))[:, :, 0, :L]
        y = (lambda x, *d: x.permute(*d))(y, 0, 2, 1) + u * Dskip[None, None, :]
        return y

    def _B_ref(x, w_gate, w_up, w_down):
        g = torch.einsum("bsd,df->bsf", x, w_gate)
        u = torch.einsum("bsd,df->bsf", x, w_up)
        h = g * u
        return torch.einsum("bsf,fd->bsd", h, w_down)

    x = A_u
    g = _sigmoid((x * gate_w).sum(-1, keepdims=True))
    a = _A_ref(x, A_A_re, A_A_im, A_B_re, A_B_im, A_C_re, A_C_im, A_log_dt, A_Dskip)
    b = _B_ref(x, B_w_gate, B_w_up, B_w_down)
    return g * a + (1 - g) * b
```

```asm
; @launch grid=(256,1,1) block=(512,1,1) lds=163840
.amdgcn_target "amdgcn-amd-amdhsa--gfx950"
.text
.globl gated_mix__ssm_conv_s4__glu_gated_bilinear__prompt_kernel
.p2align 8
.type gated_mix__ssm_conv_s4__glu_gated_bilinear__prompt_kernel,@function
gated_mix__ssm_conv_s4__glu_gated_bilinear__prompt_kernel:
    s_cmp_ge_u32 s2, 256
    s_cbranch_scc1 END
    s_load_dwordx16 s[16:31], s[0:1], 0
    s_load_dwordx16 s[32:47], s[0:1], 64
    s_load_dwordx2 s[48:49], s[0:1], 128
    s_getpc_b64 s[50:51]
PC0:
    v_lshlrev_b32 v1, 6, v0
    v_min_u32 v1, END-PC0, v1
    global_load_dword v255, v1, s[50:51]
    v_lshrrev_b32 v1, 6, v0
    v_and_b32 v0, 63, v0
    v_readfirstlane_b32 s3, v1
    s_and_b32 s9, s2, 7
    s_lshr_b32 s10, s2, 3
    s_lshr_b32 s11, s9, 2
    s_lshl_b32 s11, s11, 3
    s_and_b32 s12, s10, 7
    s_add_u32 s4, s11, s12
    s_and_b32 s11, s9, 3
    s_lshl_b32 s11, s11, 2
    s_lshr_b32 s12, s10, 3
    s_add_u32 s5, s11, s12
    s_mov_b32 s12, 0xf8cb4370
    s_mov_b32 s13, 0xaed15926
    s_lshl_b32 s11, s5, 2
    s_lshr_b64 s[12:13], s[12:13], s11
    s_and_b32 s5, s12, 15
    s_lshl_b32 s11, s9, 2
    s_and_b32 s12, s10, 3
    s_add_u32 s7, s11, s12
    s_lshr_b32 s8, s10, 2
    s_cmp_lt_u32 s3, 4
    s_cbranch_scc1 CPATH
    s_setprio 1
    s_and_b32 s14, s3, 3
    s_mul_i32 s80, s14, 8704
    s_add_u32 s80, s80, 141824
    s_lshr_b32 s9, s2, 3
    s_xor_b32 s9, s9, s2
    s_and_b32 s9, s9, 1
    s_mul_i32 s9, s9, 9
    s_xor_b32 s101, s9, s2
    s_cmp_eq_u32 s14, 3
    s_cbranch_scc1 X3PATH
    s_and_b32 s9, s101, 1
    s_add_u32 s10, s9, s14
    s_cmp_eq_u32 s10, 3
    s_cbranch_scc1 LOADONLY
    s_lshr_b32 s10, s101, 1
    s_mul_i32 s10, s10, 5
    s_mul_i32 s9, s9, 3
    s_add_u32 s10, s10, s9
    s_add_u32 s83, s10, s14
    s_mul_i32 s9, s83, 384
    v_lshl_add_u32 v14, v0, 2, s9
    v_lshl_add_u32 v15, v0, 1, s9
    s_lshl_b32 s9, s83, 1
    v_mov_b32 v16, s9
    s_waitcnt lgkmcnt(0)
    global_load_ushort v32, v16, s[30:31]
    global_load_dword v20, v14, s[18:19]
    global_load_ushort v26, v15, s[18:19] offset:256
    global_load_dword v21, v14, s[20:21]
    global_load_ushort v27, v15, s[20:21] offset:256
    global_load_dword v22, v14, s[22:23]
    global_load_ushort v28, v15, s[22:23] offset:256
    global_load_dword v23, v14, s[24:25]
    global_load_ushort v29, v15, s[24:25] offset:256
    global_load_dword v24, v14, s[26:27]
    global_load_ushort v30, v15, s[26:27] offset:256
    global_load_dword v25, v14, s[28:29]
    global_load_ushort v31, v15, s[28:29] offset:256
    global_load_ushort v33, v16, s[32:33]
    s_and_b32 s14, s3, 3
    s_lshl_b32 s12, s14, 12
    s_mul_i32 s13, s14, 3072
    s_mul_i32 s6, s14, 40960
    s_add_u32 s13, s13, 16384
    s_mul_i32 s9, s4, 163840
    v_lshrrev_b32 v10, 3, v0
    v_mul_u32_u24 v10, 1280, v10
    v_add_u32 v10, s9, v10
    v_and_b32 v11, 7, v0
    v_lshrrev_b32 v12, 4, v0
    v_xor_b32 v11, v11, v12
    v_lshl_add_u32 v2, v11, 4, v10
    v_xor_b32 v11, 4, v11
    v_lshl_add_u32 v3, v11, 4, v10
    v_add_u32 v3, 9216, v3
    v_add_u32 v4, 18432, v2
    v_add_u32 v5, 18432, v3
    s_mov_b32 s76, 0x76543210
    s_mov_b32 s77, 0x78541298
    s_lshl_b32 s9, s5, 2
    s_lshr_b64 s[76:77], s[76:77], s9
    s_and_b32 s76, s76, 15
    s_add_u32 s9, s76, 2
    s_cmp_ge_u32 s9, 10
    s_cselect_b32 s10, 10, 0
    s_sub_u32 s9, s9, s10
    s_mul_i32 s82, s9, 196608
    s_lshl_b32 s9, s9, 7
    s_add_u32 s81, s9, s6
    s_mul_i32 s9, s14, 49152
    s_mul_i32 s10, s5, 192
    s_add_u32 s9, s9, s10
    v_add_u32 v10, 0, v0
    v_mul_u32_u24 v11, 171, v10
    v_lshrrev_b32 v11, 11, v11
    v_mul_u32_u24 v11, 2880, v11
    v_lshl_add_u32 v11, v0, 4, v11
    v_add_u32 v6, s9, v11
    v_add_u32 v10, 64, v0
    v_mul_u32_u24 v11, 171, v10
    v_lshrrev_b32 v11, 11, v11
    v_mul_u32_u24 v11, 2880, v11
    v_lshl_add_u32 v11, v0, 4, v11
    v_add_u32 v7, s9, v11
    v_add_u32 v10, 128, v0
    v_mul_u32_u24 v11, 171, v10
    v_lshrrev_b32 v11, 11, v11
    v_mul_u32_u24 v11, 2880, v11
    v_lshl_add_u32 v11, v0, 4, v11
    v_add_u32 v8, s9, v11
    s_waitcnt lgkmcnt(0)
    s_mov_b32 s52, s16
    s_mov_b32 s53, s17
    s_mov_b32 s54, 2621440
    s_mov_b32 s55, 0x20000
    s_mov_b32 s56, s36
    s_mov_b32 s57, s37
    s_mov_b32 s58, 1966080
    s_mov_b32 s59, 0x20000
    s_mov_b32 s60, s38
    s_mov_b32 s61, s39
    s_mov_b32 s62, 1966080
    s_mov_b32 s63, 0x20000
    s_mov_b32 s68, s48
    s_mov_b32 s69, s49
    s_mov_b32 s70, 15728640
    s_mov_b32 s71, 0x20000
    s_sub_u32 s34, s80, 4608
    s_mul_i32 s35, s14, 16640
    s_add_u32 s35, s35, 81984
    v_lshl_add_u32 v10, v0, 2, s34
    v_add_u32 v11, 1088, v10
    v_add_u32 v12, 2176, v10
    v_add_u32 v13, 3264, v10
    v_add_u32 v14, 4352, v10
    v_add_u32 v15, 5440, v10
    v_add_u32 v16, 6528, v10
    v_add_u32 v17, 7616, v10
    v_and_b32 v18, 31, v0
    v_mul_u32_u24 v18, 272, v18
    v_lshrrev_b32 v19, 5, v0
    v_lshlrev_b32 v19, 4, v19
    v_add3_u32 v18, v18, v19, s34
    s_waitcnt vmcnt(0)
    v_lshlrev_b32 v32, 16, v32
    v_mul_f32 v32, 0x3fb8aa3b, v32
    v_exp_f32 v32, v32
    v_mov_b32 v65, 0x3c00
    v_cvt_pk_bf16_f32 v34, v32, v32
    v_lshlrev_b32 v34, 16, v34
    v_mul_f32 v35, 0x3fb8aa3b, v34
    v_mul_f32 v36, 0x3e22f983, v34
    v_lshlrev_b32 v38, 16, v22
    v_lshlrev_b32 v39, 16, v23
    v_lshlrev_b32 v40, 16, v24
    v_lshlrev_b32 v41, 16, v25
    v_mul_f32 v44, v40, v38
    v_mul_f32 v45, v40, v39
    v_fma_f32 v44, -v41, v39, v44
    v_fmac_f32 v45, v41, v38
    v_max3_f32 v66, |v44|, |v45|, 0
    v_and_b32 v38, 0xffff0000, v22
    v_and_b32 v39, 0xffff0000, v23
    v_and_b32 v40, 0xffff0000, v24
    v_and_b32 v41, 0xffff0000, v25
    v_mul_f32 v46, v40, v38
    v_mul_f32 v47, v40, v39
    v_fma_f32 v46, -v41, v39, v46
    v_fmac_f32 v47, v41, v38
    v_max3_f32 v66, |v46|, |v47|, v66
    v_lshlrev_b32 v38, 16, v28
    v_lshlrev_b32 v39, 16, v29
    v_lshlrev_b32 v40, 16, v30
    v_lshlrev_b32 v41, 16, v31
    v_mul_f32 v48, v40, v38
    v_mul_f32 v49, v40, v39
    v_fma_f32 v48, -v41, v39, v48
    v_fmac_f32 v49, v41, v38
    v_max3_f32 v66, |v48|, |v49|, v66
    s_nop 1
    v_max_f32_dpp v66, v66, v66 quad_perm:[1,0,3,2] row_mask:0xf bank_mask:0xf
    s_nop 1
    v_max_f32_dpp v66, v66, v66 quad_perm:[2,3,0,1] row_mask:0xf bank_mask:0xf
    s_nop 1
    v_max_f32_dpp v66, v66, v66 row_half_mirror row_mask:0xf bank_mask:0xf
    s_nop 1
    v_max_f32_dpp v66, v66, v66 row_mirror row_mask:0xf bank_mask:0xf
    s_nop 0
    v_readlane_b32 s9, v66, 0
    v_readlane_b32 s10, v66, 16
    v_readlane_b32 s11, v66, 32
    v_readlane_b32 s15, v66, 48
    s_max_u32 s9, s9, s10
    s_max_u32 s11, s11, s15
    s_max_u32 s9, s9, s11
    s_lshr_b32 s9, s9, 23
    s_max_u32 s9, s9, 11
    s_min_u32 s9, s9, 253
    s_sub_u32 s10, 264, s9
    s_lshl_b32 s10, s10, 23
    s_sub_u32 s9, s9, 10
    s_lshl_b32 s9, s9, 23
    v_mul_f32 v37, s9, v34
    v_mul_f32 v44, s10, v44
    v_mul_f32 v45, s10, v45
    v_mul_f32 v46, s10, v46
    v_mul_f32 v47, s10, v47
    v_mul_f32 v48, s10, v48
    v_mul_f32 v49, s10, v49
    v_lshlrev_b32 v42, 16, v20
    v_lshlrev_b32 v43, 16, v21
    v_mul_f32 v42, v42, v35
    v_mul_f32 v43, v43, v36
    v_and_b32 v112, 0xffff0000, v20
    v_and_b32 v113, 0xffff0000, v21
    v_mul_f32 v112, v112, v35
    v_mul_f32 v113, v113, v36
    v_lshlrev_b32 v114, 16, v26
    v_lshlrev_b32 v115, 16, v27
    v_mul_f32 v114, v114, v35
    v_mul_f32 v115, v115, v36
    v_cvt_pk_f16_f32 v50, v44, -v45
    v_cvt_pk_f16_f32 v51, v46, -v47
    v_cvt_pk_f16_f32 v52, v48, -v49
    v_fract_f32 v67, v43
    v_mul_f32 v72, 0x42000000, v42
    v_exp_f32 v66, v42
    v_mul_f32 v73, 0x42000000, v43
    v_cos_f32 v68, v67
    v_fract_f32 v73, v73
    v_sin_f32 v69, v67
    v_exp_f32 v72, v72
    v_cos_f32 v74, v73
    v_mul_f32 v68, v68, v66
    v_sin_f32 v75, v73
    v_mul_f32 v69, v69, v66
    v_mul_f32 v74, v74, v72
    v_cvt_pk_f16_f32 v54, v68, v69
    v_mul_f32 v75, v75, v72
    v_mul_f32 v66, v69, v69
    v_cvt_pk_f16_f32 v59, v74, v75
    v_mul_f32 v72, v75, v75
    v_add_f32 v67, v68, v68
    v_add_f32 v73, v74, v74
    v_fma_f32 v70, v68, v68, -v66
    v_fma_f32 v76, v74, v74, -v72
    v_mul_f32 v71, v67, v69
    v_mul_f32 v77, v73, v75
    v_cvt_pk_f16_f32 v55, v70, v71
    v_cvt_pk_f16_f32 v60, v76, v77
    v_mul_f32 v72, v77, v77
    v_mul_f32 v66, v71, v71
    v_add_f32 v73, v76, v76
    v_add_f32 v67, v70, v70
    v_fma_f32 v74, v76, v76, -v72
    v_fma_f32 v68, v70, v70, -v66
    v_mul_f32 v75, v73, v77
    v_mul_f32 v69, v67, v71
    v_cvt_pk_f16_f32 v61, v74, v75
    v_mul_f32 v72, v75, v75
    v_cvt_pk_f16_f32 v56, v68, v69
    v_add_f32 v73, v74, v74
    v_mul_f32 v66, v69, v69
    v_fma_f32 v76, v74, v74, -v72
    v_add_f32 v67, v68, v68
    v_mul_f32 v77, v73, v75
    v_fma_f32 v70, v68, v68, -v66
    v_cvt_pk_f16_f32 v62, v76, v77
    v_mul_f32 v72, v77, v77
    v_mul_f32 v71, v67, v69
    v_add_f32 v73, v76, v76
    v_cvt_pk_f16_f32 v57, v70, v71
    v_fma_f32 v74, v76, v76, -v72
    v_mul_f32 v66, v71, v71
    v_mul_f32 v75, v73, v77
    v_add_f32 v67, v70, v70
    v_cvt_pk_f16_f32 v63, v74, v75
    v_mul_f32 v72, v75, v75
    v_fma_f32 v68, v70, v70, -v66
    v_add_f32 v73, v74, v74
    v_mul_f32 v69, v67, v71
    v_fma_f32 v76, v74, v74, -v72
    v_cvt_pk_f16_f32 v58, v68, v69
    v_mul_f32 v77, v73, v75
    v_cvt_pk_f16_f32 v64, v76, v77
    ds_write2_b32 v10, v65, v57 offset0:0 offset1:68
    v_pk_mul_f16 v83, v57, v58 op_sel:[0,0] op_sel_hi:[0,1]
    v_pk_fma_f16 v83, v57, v58, v83 op_sel:[1,1,0] op_sel_hi:[1,0,1] neg_lo:[0,1,0]
    ds_write2_b32 v10, v58, v83 offset0:136 offset1:204
    v_pk_mul_f16 v85, v57, v59 op_sel:[0,0] op_sel_hi:[0,1]
    v_pk_mul_f16 v86, v58, v59 op_sel:[0,0] op_sel_hi:[0,1]
    v_pk_fma_f16 v85, v57, v59, v85 op_sel:[1,1,0] op_sel_hi:[1,0,1] neg_lo:[0,1,0]
    v_pk_fma_f16 v86, v58, v59, v86 op_sel:[1,1,0] op_sel_hi:[1,0,1] neg_lo:[0,1,0]
    ds_write2_b32 v11, v59, v85 offset0:0 offset1:68
    v_pk_mul_f16 v87, v83, v59 op_sel:[0,0] op_sel_hi:[0,1]
    v_pk_fma_f16 v87, v83, v59, v87 op_sel:[1,1,0] op_sel_hi:[1,0,1] neg_lo:[0,1,0]
    ds_write2_b32 v11, v86, v87 offset0:136 offset1:204
    v_pk_mul_f16 v89, v57, v60 op_sel:[0,0] op_sel_hi:[0,1]
    v_pk_mul_f16 v90, v58, v60 op_sel:[0,0] op_sel_hi:[0,1]
    v_pk_fma_f16 v89, v57, v60, v89 op_sel:[1,1,0] op_sel_hi:[1,0,1] neg_lo:[0,1,0]
    v_pk_fma_f16 v90, v58, v60, v90 op_sel:[1,1,0] op_sel_hi:[1,0,1] neg_lo:[0,1,0]
    ds_write2_b32 v12, v60, v89 offset0:0 offset1:68
    v_pk_mul_f16 v91, v83, v60 op_sel:[0,0] op_sel_hi:[0,1]
    v_pk_mul_f16 v92, v59, v60 op_sel:[0,0] op_sel_hi:[0,1]
    v_pk_fma_f16 v91, v83, v60, v91 op_sel:[1,1,0] op_sel_hi:[1,0,1] neg_lo:[0,1,0]
    v_pk_fma_f16 v92, v59, v60, v92 op_sel:[1,1,0] op_sel_hi:[1,0,1] neg_lo:[0,1,0]
    ds_write2_b32 v12, v90, v91 offset0:136 offset1:204
    v_pk_mul_f16 v93, v85, v60 op_sel:[0,0] op_sel_hi:[0,1]
    v_pk_mul_f16 v94, v86, v60 op_sel:[0,0] op_sel_hi:[0,1]
    v_pk_fma_f16 v93, v85, v60, v93 op_sel:[1,1,0] op_sel_hi:[1,0,1] neg_lo:[0,1,0]
    v_pk_fma_f16 v94, v86, v60, v94 op_sel:[1,1,0] op_sel_hi:[1,0,1] neg_lo:[0,1,0]
    ds_write2_b32 v13, v92, v93 offset0:0 offset1:68
    v_pk_mul_f16 v95, v87, v60 op_sel:[0,0] op_sel_hi:[0,1]
    v_pk_fma_f16 v95, v87, v60, v95 op_sel:[1,1,0] op_sel_hi:[1,0,1] neg_lo:[0,1,0]
    ds_write2_b32 v13, v94, v95 offset0:136 offset1:204
    v_pk_mul_f16 v97, v57, v61 op_sel:[0,0] op_sel_hi:[0,1]
    v_pk_mul_f16 v98, v58, v61 op_sel:[0,0] op_sel_hi:[0,1]
    v_pk_fma_f16 v97, v57, v61, v97 op_sel:[1,1,0] op_sel_hi:[1,0,1] neg_lo:[0,1,0]
    v_pk_fma_f16 v98, v58, v61, v98 op_sel:[1,1,0] op_sel_hi:[1,0,1] neg_lo:[0,1,0]
    ds_write2_b32 v14, v61, v97 offset0:0 offset1:68
    v_pk_mul_f16 v99, v83, v61 op_sel:[0,0] op_sel_hi:[0,1]
    v_pk_mul_f16 v100, v59, v61 op_sel:[0,0] op_sel_hi:[0,1]
    v_pk_fma_f16 v99, v83, v61, v99 op_sel:[1,1,0] op_sel_hi:[1,0,1] neg_lo:[0,1,0]
    v_pk_fma_f16 v100, v59, v61, v100 op_sel:[1,1,0] op_sel_hi:[1,0,1] neg_lo:[0,1,0]
    ds_write2_b32 v14, v98, v99 offset0:136 offset1:204
    v_pk_mul_f16 v101, v85, v61 op_sel:[0,0] op_sel_hi:[0,1]
    v_pk_mul_f16 v102, v86, v61 op_sel:[0,0] op_sel_hi:[0,1]
    v_pk_fma_f16 v101, v85, v61, v101 op_sel:[1,1,0] op_sel_hi:[1,0,1] neg_lo:[0,1,0]
    v_pk_fma_f16 v102, v86, v61, v102 op_sel:[1,1,0] op_sel_hi:[1,0,1] neg_lo:[0,1,0]
    ds_write2_b32 v15, v100, v101 offset0:0 offset1:68
    v_pk_mul_f16 v103, v87, v61 op_sel:[0,0] op_sel_hi:[0,1]
    v_pk_mul_f16 v104, v60, v61 op_sel:[0,0] op_sel_hi:[0,1]
    v_pk_fma_f16 v103, v87, v61, v103 op_sel:[1,1,0] op_sel_hi:[1,0,1] neg_lo:[0,1,0]
    v_pk_fma_f16 v104, v60, v61, v104 op_sel:[1,1,0] op_sel_hi:[1,0,1] neg_lo:[0,1,0]
    ds_write2_b32 v15, v102, v103 offset0:136 offset1:204
    v_pk_mul_f16 v105, v89, v61 op_sel:[0,0] op_sel_hi:[0,1]
    v_pk_mul_f16 v106, v90, v61 op_sel:[0,0] op_sel_hi:[0,1]
    v_pk_fma_f16 v105, v89, v61, v105 op_sel:[1,1,0] op_sel_hi:[1,0,1] neg_lo:[0,1,0]
    v_pk_fma_f16 v106, v90, v61, v106 op_sel:[1,1,0] op_sel_hi:[1,0,1] neg_lo:[0,1,0]
    ds_write2_b32 v16, v104, v105 offset0:0 offset1:68
    v_pk_mul_f16 v107, v91, v61 op_sel:[0,0] op_sel_hi:[0,1]
    v_pk_mul_f16 v108, v92, v61 op_sel:[0,0] op_sel_hi:[0,1]
    v_pk_fma_f16 v107, v91, v61, v107 op_sel:[1,1,0] op_sel_hi:[1,0,1] neg_lo:[0,1,0]
    v_pk_fma_f16 v108, v92, v61, v108 op_sel:[1,1,0] op_sel_hi:[1,0,1] neg_lo:[0,1,0]
    ds_write2_b32 v16, v106, v107 offset0:136 offset1:204
    v_pk_mul_f16 v109, v93, v61 op_sel:[0,0] op_sel_hi:[0,1]
    v_pk_mul_f16 v110, v94, v61 op_sel:[0,0] op_sel_hi:[0,1]
    v_pk_fma_f16 v109, v93, v61, v109 op_sel:[1,1,0] op_sel_hi:[1,0,1] neg_lo:[0,1,0]
    v_pk_fma_f16 v110, v94, v61, v110 op_sel:[1,1,0] op_sel_hi:[1,0,1] neg_lo:[0,1,0]
    ds_write2_b32 v17, v108, v109 offset0:0 offset1:68
    v_pk_mul_f16 v111, v95, v61 op_sel:[0,0] op_sel_hi:[0,1]
    v_pk_fma_f16 v111, v95, v61, v111 op_sel:[1,1,0] op_sel_hi:[1,0,1] neg_lo:[0,1,0]
    ds_write2_b32 v17, v110, v111 offset0:136 offset1:204
    ds_read_b128 v[128:131], v18 offset:0
    ds_read_b128 v[132:135], v18 offset:32
    ds_read_b128 v[136:139], v18 offset:64
    ds_read_b128 v[140:143], v18 offset:96
    ds_read_b128 v[144:147], v18 offset:128
    ds_read_b128 v[148:151], v18 offset:160
    ds_read_b128 v[152:155], v18 offset:192
    ds_read_b128 v[156:159], v18 offset:224
    v_pk_mul_f16 v80, v50, v54 op_sel:[0,0] op_sel_hi:[0,1] neg_hi:[0,1]
    v_pk_mul_f16 v81, v50, v55 op_sel:[0,0] op_sel_hi:[0,1] neg_hi:[0,1]
    v_pk_fma_f16 v80, v50, v54, v80 op_sel:[1,1,0] op_sel_hi:[1,0,1]
    v_pk_fma_f16 v81, v50, v55, v81 op_sel:[1,1,0] op_sel_hi:[1,0,1]
    ds_write2_b32 v10, v50, v80 offset0:0 offset1:68
    v_pk_mul_f16 v82, v80, v55 op_sel:[0,0] op_sel_hi:[0,1] neg_hi:[0,1]
    v_pk_mul_f16 v83, v50, v56 op_sel:[0,0] op_sel_hi:[0,1] neg_hi:[0,1]
    v_pk_fma_f16 v82, v80, v55, v82 op_sel:[1,1,0] op_sel_hi:[1,0,1]
    v_pk_fma_f16 v83, v50, v56, v83 op_sel:[1,1,0] op_sel_hi:[1,0,1]
    ds_write2_b32 v10, v81, v82 offset0:136 offset1:204
    v_pk_mul_f16 v84, v80, v56 op_sel:[0,0] op_sel_hi:[0,1] neg_hi:[0,1]
    v_pk_mul_f16 v85, v81, v56 op_sel:[0,0] op_sel_hi:[0,1] neg_hi:[0,1]
    v_pk_fma_f16 v84, v80, v56, v84 op_sel:[1,1,0] op_sel_hi:[1,0,1]
    v_pk_fma_f16 v85, v81, v56, v85 op_sel:[1,1,0] op_sel_hi:[1,0,1]
    ds_write2_b32 v12, v83, v84 offset0:0 offset1:68
    v_pk_mul_f16 v86, v82, v56 op_sel:[0,0] op_sel_hi:[0,1] neg_hi:[0,1]
    v_pk_mul_f16 v87, v50, v57 op_sel:[0,0] op_sel_hi:[0,1] neg_hi:[0,1]
    v_pk_fma_f16 v86, v82, v56, v86 op_sel:[1,1,0] op_sel_hi:[1,0,1]
    v_pk_fma_f16 v87, v50, v57, v87 op_sel:[1,1,0] op_sel_hi:[1,0,1]
    ds_write2_b32 v12, v85, v86 offset0:136 offset1:204
    v_pk_mul_f16 v88, v50, v62 op_sel:[0,0] op_sel_hi:[0,1] neg_hi:[0,1]
    v_pk_mul_f16 v89, v81, v62 op_sel:[0,0] op_sel_hi:[0,1] neg_hi:[0,1]
    v_pk_fma_f16 v88, v50, v62, v88 op_sel:[1,1,0] op_sel_hi:[1,0,1]
    v_pk_fma_f16 v89, v81, v62, v89 op_sel:[1,1,0] op_sel_hi:[1,0,1]
    ds_write2_b32 v14, v88, v89 offset0:0 offset1:68
    v_pk_mul_f16 v90, v83, v62 op_sel:[0,0] op_sel_hi:[0,1] neg_hi:[0,1]
    v_pk_mul_f16 v91, v85, v62 op_sel:[0,0] op_sel_hi:[0,1] neg_hi:[0,1]
    v_pk_fma_f16 v90, v83, v62, v90 op_sel:[1,1,0] op_sel_hi:[1,0,1]
    v_pk_fma_f16 v91, v85, v62, v91 op_sel:[1,1,0] op_sel_hi:[1,0,1]
    ds_write2_b32 v14, v90, v91 offset0:136 offset1:204
    v_pk_mul_f16 v92, v87, v62 op_sel:[0,0] op_sel_hi:[0,1] neg_hi:[0,1]
    v_pk_mul_f16 v93, v50, v63 op_sel:[0,0] op_sel_hi:[0,1] neg_hi:[0,1]
    v_pk_fma_f16 v92, v87, v62, v92 op_sel:[1,1,0] op_sel_hi:[1,0,1]
    v_pk_fma_f16 v93, v50, v63, v93 op_sel:[1,1,0] op_sel_hi:[1,0,1]
    ds_write2_b32 v16, v92, v93 offset0:0 offset1:68
    v_pk_mul_f16 v94, v83, v63 op_sel:[0,0] op_sel_hi:[0,1] neg_hi:[0,1]
    v_pk_mul_f16 v95, v87, v63 op_sel:[0,0] op_sel_hi:[0,1] neg_hi:[0,1]
    v_pk_fma_f16 v94, v83, v63, v94 op_sel:[1,1,0] op_sel_hi:[1,0,1]
    v_pk_fma_f16 v95, v87, v63, v95 op_sel:[1,1,0] op_sel_hi:[1,0,1]
    ds_write2_b32 v16, v94, v95 offset0:136 offset1:204
    v_pk_mul_f16 v96, v88, v63 op_sel:[0,0] op_sel_hi:[0,1] neg_hi:[0,1]
    v_pk_mul_f16 v97, v90, v63 op_sel:[0,0] op_sel_hi:[0,1] neg_hi:[0,1]
    v_pk_fma_f16 v96, v88, v63, v96 op_sel:[1,1,0] op_sel_hi:[1,0,1]
    v_pk_fma_f16 v97, v90, v63, v97 op_sel:[1,1,0] op_sel_hi:[1,0,1]
    ds_write2_b32 v11, v96, v97 offset0:0 offset1:68
    v_pk_mul_f16 v98, v92, v63 op_sel:[0,0] op_sel_hi:[0,1] neg_hi:[0,1]
    v_pk_mul_f16 v99, v50, v64 op_sel:[0,0] op_sel_hi:[0,1] neg_hi:[0,1]
    v_pk_fma_f16 v98, v92, v63, v98 op_sel:[1,1,0] op_sel_hi:[1,0,1]
    v_pk_fma_f16 v99, v50, v64, v99 op_sel:[1,1,0] op_sel_hi:[1,0,1]
    ds_write2_b32 v11, v98, v99 offset0:136 offset1:204
    v_pk_mul_f16 v100, v87, v64 op_sel:[0,0] op_sel_hi:[0,1] neg_hi:[0,1]
    v_pk_mul_f16 v101, v88, v64 op_sel:[0,0] op_sel_hi:[0,1] neg_hi:[0,1]
    v_pk_fma_f16 v100, v87, v64, v100 op_sel:[1,1,0] op_sel_hi:[1,0,1]
    v_pk_fma_f16 v101, v88, v64, v101 op_sel:[1,1,0] op_sel_hi:[1,0,1]
    ds_write2_b32 v13, v100, v101 offset0:0 offset1:68
    v_pk_mul_f16 v102, v92, v64 op_sel:[0,0] op_sel_hi:[0,1] neg_hi:[0,1]
    v_pk_mul_f16 v103, v93, v64 op_sel:[0,0] op_sel_hi:[0,1] neg_hi:[0,1]
    v_pk_fma_f16 v102, v92, v64, v102 op_sel:[1,1,0] op_sel_hi:[1,0,1]
    v_pk_fma_f16 v103, v93, v64, v103 op_sel:[1,1,0] op_sel_hi:[1,0,1]
    ds_write2_b32 v13, v102, v103 offset0:136 offset1:204
    v_pk_mul_f16 v104, v95, v64 op_sel:[0,0] op_sel_hi:[0,1] neg_hi:[0,1]
    v_pk_mul_f16 v105, v96, v64 op_sel:[0,0] op_sel_hi:[0,1] neg_hi:[0,1]
    v_pk_fma_f16 v104, v95, v64, v104 op_sel:[1,1,0] op_sel_hi:[1,0,1]
    v_pk_fma_f16 v105, v96, v64, v105 op_sel:[1,1,0] op_sel_hi:[1,0,1]
    ds_write2_b32 v15, v104, v105 offset0:0 offset1:68
    v_pk_mul_f16 v106, v98, v64 op_sel:[0,0] op_sel_hi:[0,1] neg_hi:[0,1]
    v_pk_fma_f16 v106, v98, v64, v106 op_sel:[1,1,0] op_sel_hi:[1,0,1]
    ds_write_b32 v15, v106 offset:544
    ds_read_b128 v[160:163], v18 offset:0
    ds_read_b128 v[164:167], v18 offset:32
    ds_read_b128 v[168:171], v18 offset:64
    ds_read_b128 v[172:175], v18 offset:96
    ds_read_b128 v[176:179], v18 offset:128
    ds_read_b128 v[180:183], v18 offset:160
    ds_read_b128 v[184:187], v18 offset:192
    ds_read_b128 v[188:191], v18 offset:224
    v_fract_f32 v67, v113
    v_mul_f32 v72, 0x42000000, v112
    v_exp_f32 v66, v112
    v_mul_f32 v73, 0x42000000, v113
    s_waitcnt lgkmcnt(7)
    v_mfma_f32_32x32x16_f16 v[192:207], v[160:163], v[128:131], 0
    v_cos_f32 v68, v67
    v_fract_f32 v73, v73
    v_sin_f32 v69, v67
    v_exp_f32 v72, v72
    v_cos_f32 v74, v73
    v_mul_f32 v68, v68, v66
    v_sin_f32 v75, v73
    v_mul_f32 v69, v69, v66
    s_waitcnt lgkmcnt(6)
    v_mfma_f32_32x32x16_f16 v[192:207], v[164:167], v[132:135], v[192:207]
    v_mul_f32 v74, v74, v72
    v_cvt_pk_f16_f32 v54, v68, v69
    v_mul_f32 v75, v75, v72
    v_mul_f32 v66, v69, v69
    v_cvt_pk_f16_f32 v59, v74, v75
    v_mul_f32 v72, v75, v75
    v_add_f32 v67, v68, v68
    v_add_f32 v73, v74, v74
    s_waitcnt lgkmcnt(5)
    v_mfma_f32_32x32x16_f16 v[192:207], v[168:171], v[136:139], v[192:207]
    v_fma_f32 v70, v68, v68, -v66
    v_fma_f32 v76, v74, v74, -v72
    v_mul_f32 v71, v67, v69
    v_mul_f32 v77, v73, v75
    v_cvt_pk_f16_f32 v55, v70, v71
    v_cvt_pk_f16_f32 v60, v76, v77
    v_mul_f32 v72, v77, v77
    v_mul_f32 v66, v71, v71
    s_waitcnt lgkmcnt(4)
    v_mfma_f32_32x32x16_f16 v[192:207], v[172:175], v[140:143], v[192:207]
    v_add_f32 v73, v76, v76
    v_add_f32 v67, v70, v70
    v_fma_f32 v74, v76, v76, -v72
    v_fma_f32 v68, v70, v70, -v66
    v_mul_f32 v75, v73, v77
    v_mul_f32 v69, v67, v71
    v_cvt_pk_f16_f32 v61, v74, v75
    v_mul_f32 v72, v75, v75
    s_waitcnt lgkmcnt(3)
    v_mfma_f32_32x32x16_f16 v[192:207], v[176:179], v[144:147], v[192:207]
    v_cvt_pk_f16_f32 v56, v68, v69
    v_add_f32 v73, v74, v74
    v_mul_f32 v66, v69, v69
    v_fma_f32 v76, v74, v74, -v72
    v_add_f32 v67, v68, v68
    v_mul_f32 v77, v73, v75
    v_fma_f32 v70, v68, v68, -v66
    v_cvt_pk_f16_f32 v62, v76, v77
    s_waitcnt lgkmcnt(2)
    v_mfma_f32_32x32x16_f16 v[192:207], v[180:183], v[148:151], v[192:207]
    v_mul_f32 v72, v77, v77
    v_mul_f32 v71, v67, v69
    v_add_f32 v73, v76, v76
    v_cvt_pk_f16_f32 v57, v70, v71
    v_fma_f32 v74, v76, v76, -v72
    v_mul_f32 v66, v71, v71
    v_mul_f32 v75, v73, v77
    v_add_f32 v67, v70, v70
    s_waitcnt lgkmcnt(1)
    v_mfma_f32_32x32x16_f16 v[192:207], v[184:187], v[152:155], v[192:207]
    v_cvt_pk_f16_f32 v63, v74, v75
    v_mul_f32 v72, v75, v75
    v_fma_f32 v68, v70, v70, -v66
    v_add_f32 v73, v74, v74
    v_mul_f32 v69, v67, v71
    v_fma_f32 v76, v74, v74, -v72
    v_cvt_pk_f16_f32 v58, v68, v69
    v_mul_f32 v77, v73, v75
    s_waitcnt lgkmcnt(0)
    v_mfma_f32_32x32x16_f16 v[192:207], v[188:191], v[156:159], v[192:207]
    v_cvt_pk_f16_f32 v64, v76, v77
    ds_write2_b32 v10, v65, v57 offset0:0 offset1:68
    v_pk_mul_f16 v83, v57, v58 op_sel:[0,0] op_sel_hi:[0,1]
    v_pk_fma_f16 v83, v57, v58, v83 op_sel:[1,1,0] op_sel_hi:[1,0,1] neg_lo:[0,1,0]
    ds_write2_b32 v10, v58, v83 offset0:136 offset1:204
    v_pk_mul_f16 v85, v57, v59 op_sel:[0,0] op_sel_hi:[0,1]
    v_pk_mul_f16 v86, v58, v59 op_sel:[0,0] op_sel_hi:[0,1]
    v_pk_fma_f16 v85, v57, v59, v85 op_sel:[1,1,0] op_sel_hi:[1,0,1] neg_lo:[0,1,0]
    v_pk_fma_f16 v86, v58, v59, v86 op_sel:[1,1,0] op_sel_hi:[1,0,1] neg_lo:[0,1,0]
    ds_write2_b32 v11, v59, v85 offset0:0 offset1:68
    v_pk_mul_f16 v87, v83, v59 op_sel:[0,0] op_sel_hi:[0,1]
    v_pk_fma_f16 v87, v83, v59, v87 op_sel:[1,1,0] op_sel_hi:[1,0,1] neg_lo:[0,1,0]
    ds_write2_b32 v11, v86, v87 offset0:136 offset1:204
    v_pk_mul_f16 v89, v57, v60 op_sel:[0,0] op_sel_hi:[0,1]
    v_pk_mul_f16 v90, v58, v60 op_sel:[0,0] op_sel_hi:[0,1]
    v_pk_fma_f16 v89, v57, v60, v89 op_sel:[1,1,0] op_sel_hi:[1,0,1] neg_lo:[0,1,0]
    v_pk_fma_f16 v90, v58, v60, v90 op_sel:[1,1,0] op_sel_hi:[1,0,1] neg_lo:[0,1,0]
    ds_write2_b32 v12, v60, v89 offset0:0 offset1:68
    v_pk_mul_f16 v91, v83, v60 op_sel:[0,0] op_sel_hi:[0,1]
    v_pk_mul_f16 v92, v59, v60 op_sel:[0,0] op_sel_hi:[0,1]
    v_pk_fma_f16 v91, v83, v60, v91 op_sel:[1,1,0] op_sel_hi:[1,0,1] neg_lo:[0,1,0]
    v_pk_fma_f16 v92, v59, v60, v92 op_sel:[1,1,0] op_sel_hi:[1,0,1] neg_lo:[0,1,0]
    ds_write2_b32 v12, v90, v91 offset0:136 offset1:204
    v_pk_mul_f16 v93, v85, v60 op_sel:[0,0] op_sel_hi:[0,1]
    v_pk_mul_f16 v94, v86, v60 op_sel:[0,0] op_sel_hi:[0,1]
    v_pk_fma_f16 v93, v85, v60, v93 op_sel:[1,1,0] op_sel_hi:[1,0,1] neg_lo:[0,1,0]
    v_pk_fma_f16 v94, v86, v60, v94 op_sel:[1,1,0] op_sel_hi:[1,0,1] neg_lo:[0,1,0]
    ds_write2_b32 v13, v92, v93 offset0:0 offset1:68
    v_pk_mul_f16 v95, v87, v60 op_sel:[0,0] op_sel_hi:[0,1]
    v_pk_fma_f16 v95, v87, v60, v95 op_sel:[1,1,0] op_sel_hi:[1,0,1] neg_lo:[0,1,0]
    ds_write2_b32 v13, v94, v95 offset0:136 offset1:204
    v_pk_mul_f16 v97, v57, v61 op_sel:[0,0] op_sel_hi:[0,1]
    v_pk_mul_f16 v98, v58, v61 op_sel:[0,0] op_sel_hi:[0,1]
    v_pk_fma_f16 v97, v57, v61, v97 op_sel:[1,1,0] op_sel_hi:[1,0,1] neg_lo:[0,1,0]
    v_pk_fma_f16 v98, v58, v61, v98 op_sel:[1,1,0] op_sel_hi:[1,0,1] neg_lo:[0,1,0]
    ds_write2_b32 v14, v61, v97 offset0:0 offset1:68
    v_pk_mul_f16 v99, v83, v61 op_sel:[0,0] op_sel_hi:[0,1]
    v_pk_mul_f16 v100, v59, v61 op_sel:[0,0] op_sel_hi:[0,1]
    v_pk_fma_f16 v99, v83, v61, v99 op_sel:[1,1,0] op_sel_hi:[1,0,1] neg_lo:[0,1,0]
    v_pk_fma_f16 v100, v59, v61, v100 op_sel:[1,1,0] op_sel_hi:[1,0,1] neg_lo:[0,1,0]
    ds_write2_b32 v14, v98, v99 offset0:136 offset1:204
    v_pk_mul_f16 v101, v85, v61 op_sel:[0,0] op_sel_hi:[0,1]
    v_pk_mul_f16 v102, v86, v61 op_sel:[0,0] op_sel_hi:[0,1]
    v_pk_fma_f16 v101, v85, v61, v101 op_sel:[1,1,0] op_sel_hi:[1,0,1] neg_lo:[0,1,0]
    v_pk_fma_f16 v102, v86, v61, v102 op_sel:[1,1,0] op_sel_hi:[1,0,1] neg_lo:[0,1,0]
    ds_write2_b32 v15, v100, v101 offset0:0 offset1:68
    v_pk_mul_f16 v103, v87, v61 op_sel:[0,0] op_sel_hi:[0,1]
    v_pk_mul_f16 v104, v60, v61 op_sel:[0,0] op_sel_hi:[0,1]
    v_pk_fma_f16 v103, v87, v61, v103 op_sel:[1,1,0] op_sel_hi:[1,0,1] neg_lo:[0,1,0]
    v_pk_fma_f16 v104, v60, v61, v104 op_sel:[1,1,0] op_sel_hi:[1,0,1] neg_lo:[0,1,0]
    ds_write2_b32 v15, v102, v103 offset0:136 offset1:204
    v_pk_mul_f16 v105, v89, v61 op_sel:[0,0] op_sel_hi:[0,1]
    v_pk_mul_f16 v106, v90, v61 op_sel:[0,0] op_sel_hi:[0,1]
    v_pk_fma_f16 v105, v89, v61, v105 op_sel:[1,1,0] op_sel_hi:[1,0,1] neg_lo:[0,1,0]
    v_pk_fma_f16 v106, v90, v61, v106 op_sel:[1,1,0] op_sel_hi:[1,0,1] neg_lo:[0,1,0]
    ds_write2_b32 v16, v104, v105 offset0:0 offset1:68
    v_pk_mul_f16 v107, v91, v61 op_sel:[0,0] op_sel_hi:[0,1]
    v_pk_mul_f16 v108, v92, v61 op_sel:[0,0] op_sel_hi:[0,1]
    v_pk_fma_f16 v107, v91, v61, v107 op_sel:[1,1,0] op_sel_hi:[1,0,1] neg_lo:[0,1,0]
    v_pk_fma_f16 v108, v92, v61, v108 op_sel:[1,1,0] op_sel_hi:[1,0,1] neg_lo:[0,1,0]
    ds_write2_b32 v16, v106, v107 offset0:136 offset1:204
    v_pk_mul_f16 v109, v93, v61 op_sel:[0,0] op_sel_hi:[0,1]
    v_pk_mul_f16 v110, v94, v61 op_sel:[0,0] op_sel_hi:[0,1]
    v_pk_fma_f16 v109, v93, v61, v109 op_sel:[1,1,0] op_sel_hi:[1,0,1] neg_lo:[0,1,0]
    v_pk_fma_f16 v110, v94, v61, v110 op_sel:[1,1,0] op_sel_hi:[1,0,1] neg_lo:[0,1,0]
    ds_write2_b32 v17, v108, v109 offset0:0 offset1:68
    v_pk_mul_f16 v111, v95, v61 op_sel:[0,0] op_sel_hi:[0,1]
    v_pk_fma_f16 v111, v95, v61, v111 op_sel:[1,1,0] op_sel_hi:[1,0,1] neg_lo:[0,1,0]
    ds_write2_b32 v17, v110, v111 offset0:136 offset1:204
    ds_read_b128 v[128:131], v18 offset:0
    ds_read_b128 v[132:135], v18 offset:32
    ds_read_b128 v[136:139], v18 offset:64
    ds_read_b128 v[140:143], v18 offset:96
    ds_read_b128 v[144:147], v18 offset:128
    ds_read_b128 v[148:151], v18 offset:160
    ds_read_b128 v[152:155], v18 offset:192
    ds_read_b128 v[156:159], v18 offset:224
    v_pk_mul_f16 v80, v51, v54 op_sel:[0,0] op_sel_hi:[0,1] neg_hi:[0,1]
    v_pk_mul_f16 v81, v51, v55 op_sel:[0,0] op_sel_hi:[0,1] neg_hi:[0,1]
    v_pk_fma_f16 v80, v51, v54, v80 op_sel:[1,1,0] op_sel_hi:[1,0,1]
    v_pk_fma_f16 v81, v51, v55, v81 op_sel:[1,1,0] op_sel_hi:[1,0,1]
    ds_write2_b32 v10, v51, v80 offset0:0 offset1:68
    v_pk_mul_f16 v82, v80, v55 op_sel:[0,0] op_sel_hi:[0,1] neg_hi:[0,1]
    v_pk_mul_f16 v83, v51, v56 op_sel:[0,0] op_sel_hi:[0,1] neg_hi:[0,1]
    v_pk_fma_f16 v82, v80, v55, v82 op_sel:[1,1,0] op_sel_hi:[1,0,1]
    v_pk_fma_f16 v83, v51, v56, v83 op_sel:[1,1,0] op_sel_hi:[1,0,1]
    ds_write2_b32 v10, v81, v82 offset0:136 offset1:204
    v_pk_mul_f16 v84, v80, v56 op_sel:[0,0] op_sel_hi:[0,1] neg_hi:[0,1]
    v_pk_mul_f16 v85, v81, v56 op_sel:[0,0] op_sel_hi:[0,1] neg_hi:[0,1]
    v_pk_fma_f16 v84, v80, v56, v84 op_sel:[1,1,0] op_sel_hi:[1,0,1]
    v_pk_fma_f16 v85, v81, v56, v85 op_sel:[1,1,0] op_sel_hi:[1,0,1]
    ds_write2_b32 v12, v83, v84 offset0:0 offset1:68
    v_pk_mul_f16 v86, v82, v56 op_sel:[0,0] op_sel_hi:[0,1] neg_hi:[0,1]
    v_pk_mul_f16 v87, v51, v57 op_sel:[0,0] op_sel_hi:[0,1] neg_hi:[0,1]
    v_pk_fma_f16 v86, v82, v56, v86 op_sel:[1,1,0] op_sel_hi:[1,0,1]
    v_pk_fma_f16 v87, v51, v57, v87 op_sel:[1,1,0] op_sel_hi:[1,0,1]
    ds_write2_b32 v12, v85, v86 offset0:136 offset1:204
    v_pk_mul_f16 v88, v51, v62 op_sel:[0,0] op_sel_hi:[0,1] neg_hi:[0,1]
    v_pk_mul_f16 v89, v81, v62 op_sel:[0,0] op_sel_hi:[0,1] neg_hi:[0,1]
    v_pk_fma_f16 v88, v51, v62, v88 op_sel:[1,1,0] op_sel_hi:[1,0,1]
    v_pk_fma_f16 v89, v81, v62, v89 op_sel:[1,1,0] op_sel_hi:[1,0,1]
    ds_write2_b32 v14, v88, v89 offset0:0 offset1:68
    v_pk_mul_f16 v90, v83, v62 op_sel:[0,0] op_sel_hi:[0,1] neg_hi:[0,1]
    v_pk_mul_f16 v91, v85, v62 op_sel:[0,0] op_sel_hi:[0,1] neg_hi:[0,1]
    v_pk_fma_f16 v90, v83, v62, v90 op_sel:[1,1,0] op_sel_hi:[1,0,1]
    v_pk_fma_f16 v91, v85, v62, v91 op_sel:[1,1,0] op_sel_hi:[1,0,1]
    ds_write2_b32 v14, v90, v91 offset0:136 offset1:204
    v_pk_mul_f16 v92, v87, v62 op_sel:[0,0] op_sel_hi:[0,1] neg_hi:[0,1]
    v_pk_mul_f16 v93, v51, v63 op_sel:[0,0] op_sel_hi:[0,1] neg_hi:[0,1]
    v_pk_fma_f16 v92, v87, v62, v92 op_sel:[1,1,0] op_sel_hi:[1,0,1]
    v_pk_fma_f16 v93, v51, v63, v93 op_sel:[1,1,0] op_sel_hi:[1,0,1]
    ds_write2_b32 v16, v92, v93 offset0:0 offset1:68
    v_pk_mul_f16 v94, v83, v63 op_sel:[0,0] op_sel_hi:[0,1] neg_hi:[0,1]
    v_pk_mul_f16 v95, v87, v63 op_sel:[0,0] op_sel_hi:[0,1] neg_hi:[0,1]
    v_pk_fma_f16 v94, v83, v63, v94 op_sel:[1,1,0] op_sel_hi:[1,0,1]
    v_pk_fma_f16 v95, v87, v63, v95 op_sel:[1,1,0] op_sel_hi:[1,0,1]
    ds_write2_b32 v16, v94, v95 offset0:136 offset1:204
    v_pk_mul_f16 v96, v88, v63 op_sel:[0,0] op_sel_hi:[0,1] neg_hi:[0,1]
    v_pk_mul_f16 v97, v90, v63 op_sel:[0,0] op_sel_hi:[0,1] neg_hi:[0,1]
    v_pk_fma_f16 v96, v88, v63, v96 op_sel:[1,1,0] op_sel_hi:[1,0,1]
    v_pk_fma_f16 v97, v90, v63, v97 op_sel:[1,1,0] op_sel_hi:[1,0,1]
    ds_write2_b32 v11, v96, v97 offset0:0 offset1:68
    v_pk_mul_f16 v98, v92, v63 op_sel:[0,0] op_sel_hi:[0,1] neg_hi:[0,1]
    v_pk_mul_f16 v99, v51, v64 op_sel:[0,0] op_sel_hi:[0,1] neg_hi:[0,1]
    v_pk_fma_f16 v98, v92, v63, v98 op_sel:[1,1,0] op_sel_hi:[1,0,1]
    v_pk_fma_f16 v99, v51, v64, v99 op_sel:[1,1,0] op_sel_hi:[1,0,1]
    ds_write2_b32 v11, v98, v99 offset0:136 offset1:204
    v_pk_mul_f16 v100, v87, v64 op_sel:[0,0] op_sel_hi:[0,1] neg_hi:[0,1]
    v_pk_mul_f16 v101, v88, v64 op_sel:[0,0] op_sel_hi:[0,1] neg_hi:[0,1]
    v_pk_fma_f16 v100, v87, v64, v100 op_sel:[1,1,0] op_sel_hi:[1,0,1]
    v_pk_fma_f16 v101, v88, v64, v101 op_sel:[1,1,0] op_sel_hi:[1,0,1]
    ds_write2_b32 v13, v100, v101 offset0:0 offset1:68
    v_pk_mul_f16 v102, v92, v64 op_sel:[0,0] op_sel_hi:[0,1] neg_hi:[0,1]
    v_pk_mul_f16 v103, v93, v64 op_sel:[0,0] op_sel_hi:[0,1] neg_hi:[0,1]
    v_pk_fma_f16 v102, v92, v64, v102 op_sel:[1,1,0] op_sel_hi:[1,0,1]
    v_pk_fma_f16 v103, v93, v64, v103 op_sel:[1,1,0] op_sel_hi:[1,0,1]
    ds_write2_b32 v13, v102, v103 offset0:136 offset1:204
    v_pk_mul_f16 v104, v95, v64 op_sel:[0,0] op_sel_hi:[0,1] neg_hi:[0,1]
    v_pk_mul_f16 v105, v96, v64 op_sel:[0,0] op_sel_hi:[0,1] neg_hi:[0,1]
    v_pk_fma_f16 v104, v95, v64, v104 op_sel:[1,1,0] op_sel_hi:[1,0,1]
    v_pk_fma_f16 v105, v96, v64, v105 op_sel:[1,1,0] op_sel_hi:[1,0,1]
    ds_write2_b32 v15, v104, v105 offset0:0 offset1:68
    v_pk_mul_f16 v106, v98, v64 op_sel:[0,0] op_sel_hi:[0,1] neg_hi:[0,1]
    v_pk_fma_f16 v106, v98, v64, v106 op_sel:[1,1,0] op_sel_hi:[1,0,1]
    ds_write_b32 v15, v106 offset:544
    ds_read_b128 v[160:163], v18 offset:0
    ds_read_b128 v[164:167], v18 offset:32
    ds_read_b128 v[168:171], v18 offset:64
    ds_read_b128 v[172:175], v18 offset:96
    ds_read_b128 v[176:179], v18 offset:128
    ds_read_b128 v[180:183], v18 offset:160
    ds_read_b128 v[184:187], v18 offset:192
    ds_read_b128 v[188:191], v18 offset:224
    v_fract_f32 v67, v115
    v_mul_f32 v72, 0x42000000, v114
    v_exp_f32 v66, v114
    v_mul_f32 v73, 0x42000000, v115
    s_waitcnt lgkmcnt(7)
    v_mfma_f32_32x32x16_f16 v[192:207], v[160:163], v[128:131], v[192:207]
    v_cos_f32 v68, v67
    v_fract_f32 v73, v73
    v_sin_f32 v69, v67
    v_exp_f32 v72, v72
    v_cos_f32 v74, v73
    v_mul_f32 v68, v68, v66
    v_sin_f32 v75, v73
    v_mul_f32 v69, v69, v66
    s_waitcnt lgkmcnt(6)
    v_mfma_f32_32x32x16_f16 v[192:207], v[164:167], v[132:135], v[192:207]
    v_mul_f32 v74, v74, v72
    v_cvt_pk_f16_f32 v54, v68, v69
    v_mul_f32 v75, v75, v72
    v_mul_f32 v66, v69, v69
    v_cvt_pk_f16_f32 v59, v74, v75
    v_mul_f32 v72, v75, v75
    v_add_f32 v67, v68, v68
    v_add_f32 v73, v74, v74
    s_waitcnt lgkmcnt(5)
    v_mfma_f32_32x32x16_f16 v[192:207], v[168:171], v[136:139], v[192:207]
    v_fma_f32 v70, v68, v68, -v66
    v_fma_f32 v76, v74, v74, -v72
    v_mul_f32 v71, v67, v69
    v_mul_f32 v77, v73, v75
    v_cvt_pk_f16_f32 v55, v70, v71
    v_cvt_pk_f16_f32 v60, v76, v77
    v_mul_f32 v72, v77, v77
    v_mul_f32 v66, v71, v71
    s_waitcnt lgkmcnt(4)
    v_mfma_f32_32x32x16_f16 v[192:207], v[172:175], v[140:143], v[192:207]
    v_add_f32 v73, v76, v76
    v_add_f32 v67, v70, v70
    v_fma_f32 v74, v76, v76, -v72
    v_fma_f32 v68, v70, v70, -v66
    v_mul_f32 v75, v73, v77
    v_mul_f32 v69, v67, v71
    v_cvt_pk_f16_f32 v61, v74, v75
    v_mul_f32 v72, v75, v75
    s_waitcnt lgkmcnt(3)
    v_mfma_f32_32x32x16_f16 v[192:207], v[176:179], v[144:147], v[192:207]
    v_cvt_pk_f16_f32 v56, v68, v69
    v_add_f32 v73, v74, v74
    v_mul_f32 v66, v69, v69
    v_fma_f32 v76, v74, v74, -v72
    v_add_f32 v67, v68, v68
    v_mul_f32 v77, v73, v75
    v_fma_f32 v70, v68, v68, -v66
    v_cvt_pk_f16_f32 v62, v76, v77
    s_waitcnt lgkmcnt(2)
    v_mfma_f32_32x32x16_f16 v[192:207], v[180:183], v[148:151], v[192:207]
    v_mul_f32 v72, v77, v77
    v_mul_f32 v71, v67, v69
    v_add_f32 v73, v76, v76
    v_cvt_pk_f16_f32 v57, v70, v71
    v_fma_f32 v74, v76, v76, -v72
    v_mul_f32 v66, v71, v71
    v_mul_f32 v75, v73, v77
    v_add_f32 v67, v70, v70
    s_waitcnt lgkmcnt(1)
    v_mfma_f32_32x32x16_f16 v[192:207], v[184:187], v[152:155], v[192:207]
    v_cvt_pk_f16_f32 v63, v74, v75
    v_mul_f32 v72, v75, v75
    v_fma_f32 v68, v70, v70, -v66
    v_add_f32 v73, v74, v74
    v_mul_f32 v69, v67, v71
    v_fma_f32 v76, v74, v74, -v72
    v_cvt_pk_f16_f32 v58, v68, v69
    v_mul_f32 v77, v73, v75
    s_waitcnt lgkmcnt(0)
    v_mfma_f32_32x32x16_f16 v[192:207], v[188:191], v[156:159], v[192:207]
    v_cvt_pk_f16_f32 v64, v76, v77
    ds_write2_b32 v10, v65, v57 offset0:0 offset1:68
    v_pk_mul_f16 v83, v57, v58 op_sel:[0,0] op_sel_hi:[0,1]
    v_pk_fma_f16 v83, v57, v58, v83 op_sel:[1,1,0] op_sel_hi:[1,0,1] neg_lo:[0,1,0]
    ds_write2_b32 v10, v58, v83 offset0:136 offset1:204
    v_pk_mul_f16 v85, v57, v59 op_sel:[0,0] op_sel_hi:[0,1]
    v_pk_mul_f16 v86, v58, v59 op_sel:[0,0] op_sel_hi:[0,1]
    v_pk_fma_f16 v85, v57, v59, v85 op_sel:[1,1,0] op_sel_hi:[1,0,1] neg_lo:[0,1,0]
    v_pk_fma_f16 v86, v58, v59, v86 op_sel:[1,1,0] op_sel_hi:[1,0,1] neg_lo:[0,1,0]
    ds_write2_b32 v11, v59, v85 offset0:0 offset1:68
    v_pk_mul_f16 v87, v83, v59 op_sel:[0,0] op_sel_hi:[0,1]
    v_pk_fma_f16 v87, v83, v59, v87 op_sel:[1,1,0] op_sel_hi:[1,0,1] neg_lo:[0,1,0]
    ds_write2_b32 v11, v86, v87 offset0:136 offset1:204
    v_pk_mul_f16 v89, v57, v60 op_sel:[0,0] op_sel_hi:[0,1]
    v_pk_mul_f16 v90, v58, v60 op_sel:[0,0] op_sel_hi:[0,1]
    v_pk_fma_f16 v89, v57, v60, v89 op_sel:[1,1,0] op_sel_hi:[1,0,1] neg_lo:[0,1,0]
    v_pk_fma_f16 v90, v58, v60, v90 op_sel:[1,1,0] op_sel_hi:[1,0,1] neg_lo:[0,1,0]
    ds_write2_b32 v12, v60, v89 offset0:0 offset1:68
    v_pk_mul_f16 v91, v83, v60 op_sel:[0,0] op_sel_hi:[0,1]
    v_pk_mul_f16 v92, v59, v60 op_sel:[0,0] op_sel_hi:[0,1]
    v_pk_fma_f16 v91, v83, v60, v91 op_sel:[1,1,0] op_sel_hi:[1,0,1] neg_lo:[0,1,0]
    v_pk_fma_f16 v92, v59, v60, v92 op_sel:[1,1,0] op_sel_hi:[1,0,1] neg_lo:[0,1,0]
    ds_write2_b32 v12, v90, v91 offset0:136 offset1:204
    v_pk_mul_f16 v93, v85, v60 op_sel:[0,0] op_sel_hi:[0,1]
    v_pk_mul_f16 v94, v86, v60 op_sel:[0,0] op_sel_hi:[0,1]
    v_pk_fma_f16 v93, v85, v60, v93 op_sel:[1,1,0] op_sel_hi:[1,0,1] neg_lo:[0,1,0]
    v_pk_fma_f16 v94, v86, v60, v94 op_sel:[1,1,0] op_sel_hi:[1,0,1] neg_lo:[0,1,0]
    ds_write2_b32 v13, v92, v93 offset0:0 offset1:68
    v_pk_mul_f16 v95, v87, v60 op_sel:[0,0] op_sel_hi:[0,1]
    v_pk_fma_f16 v95, v87, v60, v95 op_sel:[1,1,0] op_sel_hi:[1,0,1] neg_lo:[0,1,0]
    ds_write2_b32 v13, v94, v95 offset0:136 offset1:204
    v_pk_mul_f16 v97, v57, v61 op_sel:[0,0] op_sel_hi:[0,1]
    v_pk_mul_f16 v98, v58, v61 op_sel:[0,0] op_sel_hi:[0,1]
    v_pk_fma_f16 v97, v57, v61, v97 op_sel:[1,1,0] op_sel_hi:[1,0,1] neg_lo:[0,1,0]
    v_pk_fma_f16 v98, v58, v61, v98 op_sel:[1,1,0] op_sel_hi:[1,0,1] neg_lo:[0,1,0]
    ds_write2_b32 v14, v61, v97 offset0:0 offset1:68
    v_pk_mul_f16 v99, v83, v61 op_sel:[0,0] op_sel_hi:[0,1]
    v_pk_mul_f16 v100, v59, v61 op_sel:[0,0] op_sel_hi:[0,1]
    v_pk_fma_f16 v99, v83, v61, v99 op_sel:[1,1,0] op_sel_hi:[1,0,1] neg_lo:[0,1,0]
    v_pk_fma_f16 v100, v59, v61, v100 op_sel:[1,1,0] op_sel_hi:[1,0,1] neg_lo:[0,1,0]
    ds_write2_b32 v14, v98, v99 offset0:136 offset1:204
    v_pk_mul_f16 v101, v85, v61 op_sel:[0,0] op_sel_hi:[0,1]
    v_pk_mul_f16 v102, v86, v61 op_sel:[0,0] op_sel_hi:[0,1]
    v_pk_fma_f16 v101, v85, v61, v101 op_sel:[1,1,0] op_sel_hi:[1,0,1] neg_lo:[0,1,0]
    v_pk_fma_f16 v102, v86, v61, v102 op_sel:[1,1,0] op_sel_hi:[1,0,1] neg_lo:[0,1,0]
    ds_write2_b32 v15, v100, v101 offset0:0 offset1:68
    v_pk_mul_f16 v103, v87, v61 op_sel:[0,0] op_sel_hi:[0,1]
    v_pk_mul_f16 v104, v60, v61 op_sel:[0,0] op_sel_hi:[0,1]
    v_pk_fma_f16 v103, v87, v61, v103 op_sel:[1,1,0] op_sel_hi:[1,0,1] neg_lo:[0,1,0]
    v_pk_fma_f16 v104, v60, v61, v104 op_sel:[1,1,0] op_sel_hi:[1,0,1] neg_lo:[0,1,0]
    ds_write2_b32 v15, v102, v103 offset0:136 offset1:204
    v_pk_mul_f16 v105, v89, v61 op_sel:[0,0] op_sel_hi:[0,1]
    v_pk_mul_f16 v106, v90, v61 op_sel:[0,0] op_sel_hi:[0,1]
    v_pk_fma_f16 v105, v89, v61, v105 op_sel:[1,1,0] op_sel_hi:[1,0,1] neg_lo:[0,1,0]
    v_pk_fma_f16 v106, v90, v61, v106 op_sel:[1,1,0] op_sel_hi:[1,0,1] neg_lo:[0,1,0]
    ds_write2_b32 v16, v104, v105 offset0:0 offset1:68
    v_pk_mul_f16 v107, v91, v61 op_sel:[0,0] op_sel_hi:[0,1]
    v_pk_mul_f16 v108, v92, v61 op_sel:[0,0] op_sel_hi:[0,1]
    v_pk_fma_f16 v107, v91, v61, v107 op_sel:[1,1,0] op_sel_hi:[1,0,1] neg_lo:[0,1,0]
    v_pk_fma_f16 v108, v92, v61, v108 op_sel:[1,1,0] op_sel_hi:[1,0,1] neg_lo:[0,1,0]
    ds_write2_b32 v16, v106, v107 offset0:136 offset1:204
    v_pk_mul_f16 v109, v93, v61 op_sel:[0,0] op_sel_hi:[0,1]
    v_pk_mul_f16 v110, v94, v61 op_sel:[0,0] op_sel_hi:[0,1]
    v_pk_fma_f16 v109, v93, v61, v109 op_sel:[1,1,0] op_sel_hi:[1,0,1] neg_lo:[0,1,0]
    v_pk_fma_f16 v110, v94, v61, v110 op_sel:[1,1,0] op_sel_hi:[1,0,1] neg_lo:[0,1,0]
    ds_write2_b32 v17, v108, v109 offset0:0 offset1:68
    v_pk_mul_f16 v111, v95, v61 op_sel:[0,0] op_sel_hi:[0,1]
    v_pk_fma_f16 v111, v95, v61, v111 op_sel:[1,1,0] op_sel_hi:[1,0,1] neg_lo:[0,1,0]
    ds_write2_b32 v17, v110, v111 offset0:136 offset1:204
    ds_read_b128 v[128:131], v18 offset:0
    ds_read_b128 v[132:135], v18 offset:32
    ds_read_b128 v[136:139], v18 offset:64
    ds_read_b128 v[140:143], v18 offset:96
    ds_read_b128 v[144:147], v18 offset:128
    ds_read_b128 v[148:151], v18 offset:160
    ds_read_b128 v[152:155], v18 offset:192
    ds_read_b128 v[156:159], v18 offset:224
    v_pk_mul_f16 v80, v52, v54 op_sel:[0,0] op_sel_hi:[0,1] neg_hi:[0,1]
    v_pk_mul_f16 v81, v52, v55 op_sel:[0,0] op_sel_hi:[0,1] neg_hi:[0,1]
    v_pk_fma_f16 v80, v52, v54, v80 op_sel:[1,1,0] op_sel_hi:[1,0,1]
    v_pk_fma_f16 v81, v52, v55, v81 op_sel:[1,1,0] op_sel_hi:[1,0,1]
    ds_write2_b32 v10, v52, v80 offset0:0 offset1:68
    v_pk_mul_f16 v82, v80, v55 op_sel:[0,0] op_sel_hi:[0,1] neg_hi:[0,1]
    v_pk_mul_f16 v83, v52, v56 op_sel:[0,0] op_sel_hi:[0,1] neg_hi:[0,1]
    v_pk_fma_f16 v82, v80, v55, v82 op_sel:[1,1,0] op_sel_hi:[1,0,1]
    v_pk_fma_f16 v83, v52, v56, v83 op_sel:[1,1,0] op_sel_hi:[1,0,1]
    ds_write2_b32 v10, v81, v82 offset0:136 offset1:204
    v_pk_mul_f16 v84, v80, v56 op_sel:[0,0] op_sel_hi:[0,1] neg_hi:[0,1]
    v_pk_mul_f16 v85, v81, v56 op_sel:[0,0] op_sel_hi:[0,1] neg_hi:[0,1]
    v_pk_fma_f16 v84, v80, v56, v84 op_sel:[1,1,0] op_sel_hi:[1,0,1]
    v_pk_fma_f16 v85, v81, v56, v85 op_sel:[1,1,0] op_sel_hi:[1,0,1]
    ds_write2_b32 v12, v83, v84 offset0:0 offset1:68
    v_pk_mul_f16 v86, v82, v56 op_sel:[0,0] op_sel_hi:[0,1] neg_hi:[0,1]
    v_pk_mul_f16 v87, v52, v57 op_sel:[0,0] op_sel_hi:[0,1] neg_hi:[0,1]
    v_pk_fma_f16 v86, v82, v56, v86 op_sel:[1,1,0] op_sel_hi:[1,0,1]
    v_pk_fma_f16 v87, v52, v57, v87 op_sel:[1,1,0] op_sel_hi:[1,0,1]
    ds_write2_b32 v12, v85, v86 offset0:136 offset1:204
    v_pk_mul_f16 v88, v52, v62 op_sel:[0,0] op_sel_hi:[0,1] neg_hi:[0,1]
    v_pk_mul_f16 v89, v81, v62 op_sel:[0,0] op_sel_hi:[0,1] neg_hi:[0,1]
    v_pk_fma_f16 v88, v52, v62, v88 op_sel:[1,1,0] op_sel_hi:[1,0,1]
    v_pk_fma_f16 v89, v81, v62, v89 op_sel:[1,1,0] op_sel_hi:[1,0,1]
    ds_write2_b32 v14, v88, v89 offset0:0 offset1:68
    v_pk_mul_f16 v90, v83, v62 op_sel:[0,0] op_sel_hi:[0,1] neg_hi:[0,1]
    v_pk_mul_f16 v91, v85, v62 op_sel:[0,0] op_sel_hi:[0,1] neg_hi:[0,1]
    v_pk_fma_f16 v90, v83, v62, v90 op_sel:[1,1,0] op_sel_hi:[1,0,1]
    v_pk_fma_f16 v91, v85, v62, v91 op_sel:[1,1,0] op_sel_hi:[1,0,1]
    ds_write2_b32 v14, v90, v91 offset0:136 offset1:204
    v_pk_mul_f16 v92, v87, v62 op_sel:[0,0] op_sel_hi:[0,1] neg_hi:[0,1]
    v_pk_mul_f16 v93, v52, v63 op_sel:[0,0] op_sel_hi:[0,1] neg_hi:[0,1]
    v_pk_fma_f16 v92, v87, v62, v92 op_sel:[1,1,0] op_sel_hi:[1,0,1]
    v_pk_fma_f16 v93, v52, v63, v93 op_sel:[1,1,0] op_sel_hi:[1,0,1]
    ds_write2_b32 v16, v92, v93 offset0:0 offset1:68
    v_pk_mul_f16 v94, v83, v63 op_sel:[0,0] op_sel_hi:[0,1] neg_hi:[0,1]
    v_pk_mul_f16 v95, v87, v63 op_sel:[0,0] op_sel_hi:[0,1] neg_hi:[0,1]
    v_pk_fma_f16 v94, v83, v63, v94 op_sel:[1,1,0] op_sel_hi:[1,0,1]
    v_pk_fma_f16 v95, v87, v63, v95 op_sel:[1,1,0] op_sel_hi:[1,0,1]
    ds_write2_b32 v16, v94, v95 offset0:136 offset1:204
    v_pk_mul_f16 v96, v88, v63 op_sel:[0,0] op_sel_hi:[0,1] neg_hi:[0,1]
    v_pk_mul_f16 v97, v90, v63 op_sel:[0,0] op_sel_hi:[0,1] neg_hi:[0,1]
    v_pk_fma_f16 v96, v88, v63, v96 op_sel:[1,1,0] op_sel_hi:[1,0,1]
    v_pk_fma_f16 v97, v90, v63, v97 op_sel:[1,1,0] op_sel_hi:[1,0,1]
    ds_write2_b32 v11, v96, v97 offset0:0 offset1:68
    v_pk_mul_f16 v98, v92, v63 op_sel:[0,0] op_sel_hi:[0,1] neg_hi:[0,1]
    v_pk_mul_f16 v99, v52, v64 op_sel:[0,0] op_sel_hi:[0,1] neg_hi:[0,1]
    v_pk_fma_f16 v98, v92, v63, v98 op_sel:[1,1,0] op_sel_hi:[1,0,1]
    v_pk_fma_f16 v99, v52, v64, v99 op_sel:[1,1,0] op_sel_hi:[1,0,1]
    ds_write2_b32 v11, v98, v99 offset0:136 offset1:204
    v_pk_mul_f16 v100, v87, v64 op_sel:[0,0] op_sel_hi:[0,1] neg_hi:[0,1]
    v_pk_mul_f16 v101, v88, v64 op_sel:[0,0] op_sel_hi:[0,1] neg_hi:[0,1]
    v_pk_fma_f16 v100, v87, v64, v100 op_sel:[1,1,0] op_sel_hi:[1,0,1]
    v_pk_fma_f16 v101, v88, v64, v101 op_sel:[1,1,0] op_sel_hi:[1,0,1]
    ds_write2_b32 v13, v100, v101 offset0:0 offset1:68
    v_pk_mul_f16 v102, v92, v64 op_sel:[0,0] op_sel_hi:[0,1] neg_hi:[0,1]
    v_pk_mul_f16 v103, v93, v64 op_sel:[0,0] op_sel_hi:[0,1] neg_hi:[0,1]
    v_pk_fma_f16 v102, v92, v64, v102 op_sel:[1,1,0] op_sel_hi:[1,0,1]
    v_pk_fma_f16 v103, v93, v64, v103 op_sel:[1,1,0] op_sel_hi:[1,0,1]
    ds_write2_b32 v13, v102, v103 offset0:136 offset1:204
    v_pk_mul_f16 v104, v95, v64 op_sel:[0,0] op_sel_hi:[0,1] neg_hi:[0,1]
    v_pk_mul_f16 v105, v96, v64 op_sel:[0,0] op_sel_hi:[0,1] neg_hi:[0,1]
    v_pk_fma_f16 v104, v95, v64, v104 op_sel:[1,1,0] op_sel_hi:[1,0,1]
    v_pk_fma_f16 v105, v96, v64, v105 op_sel:[1,1,0] op_sel_hi:[1,0,1]
    ds_write2_b32 v15, v104, v105 offset0:0 offset1:68
    v_pk_mul_f16 v106, v98, v64 op_sel:[0,0] op_sel_hi:[0,1] neg_hi:[0,1]
    v_pk_fma_f16 v106, v98, v64, v106 op_sel:[1,1,0] op_sel_hi:[1,0,1]
    ds_write_b32 v15, v106 offset:544
    ds_read_b128 v[160:163], v18 offset:0
    ds_read_b128 v[164:167], v18 offset:32
    ds_read_b128 v[168:171], v18 offset:64
    ds_read_b128 v[172:175], v18 offset:96
    ds_read_b128 v[176:179], v18 offset:128
    ds_read_b128 v[180:183], v18 offset:160
    ds_read_b128 v[184:187], v18 offset:192
    ds_read_b128 v[188:191], v18 offset:224
    s_waitcnt lgkmcnt(7)
    v_mfma_f32_32x32x16_f16 v[192:207], v[160:163], v[128:131], v[192:207]
    s_waitcnt lgkmcnt(6)
    v_mfma_f32_32x32x16_f16 v[192:207], v[164:167], v[132:135], v[192:207]
    s_waitcnt lgkmcnt(5)
    v_mfma_f32_32x32x16_f16 v[192:207], v[168:171], v[136:139], v[192:207]
    s_waitcnt lgkmcnt(4)
    v_mfma_f32_32x32x16_f16 v[192:207], v[172:175], v[140:143], v[192:207]
    s_waitcnt lgkmcnt(3)
    v_mfma_f32_32x32x16_f16 v[192:207], v[176:179], v[144:147], v[192:207]
    s_waitcnt lgkmcnt(2)
    v_mfma_f32_32x32x16_f16 v[192:207], v[180:183], v[148:151], v[192:207]
    s_waitcnt lgkmcnt(1)
    v_mfma_f32_32x32x16_f16 v[192:207], v[184:187], v[152:155], v[192:207]
    s_waitcnt lgkmcnt(0)
    v_mfma_f32_32x32x16_f16 v[192:207], v[188:191], v[156:159], v[192:207]
    s_barrier
    s_add_u32 m0, s12, 0
    s_nop 0
    buffer_load_dwordx4 v2, s[52:55], s81 offen offset:0 lds
    buffer_load_dwordx4 v3, s[52:55], s81 offen offset:1024 lds
    buffer_load_dwordx4 v4, s[52:55], s81 offen offset:2048 lds
    buffer_load_dwordx4 v5, s[52:55], s81 offen offset:3072 lds
    s_add_u32 m0, s13, 0
    s_add_u32 s81, s81, 128
    buffer_load_dwordx4 v6, s[56:59], s82 offen offset:0 lds
    buffer_load_dwordx4 v7, s[56:59], s82 offen offset:1024 lds
    buffer_load_dwordx4 v8, s[56:59], s82 offen offset:2048 lds
    s_add_u32 m0, s13, 12320
    s_nop 0
    buffer_load_dwordx4 v6, s[60:63], s82 offen offset:0 lds
    buffer_load_dwordx4 v7, s[60:63], s82 offen offset:1024 lds
    buffer_load_dwordx4 v8, s[60:63], s82 offen offset:2048 lds
    s_add_u32 s82, s82, 196608
    s_cmp_eq_u32 s82, 1966080
    s_cselect_b32 s82, 0, s82
    s_cselect_b32 s81, s6, s81
    s_barrier
    s_add_u32 m0, s12, 40992
    s_nop 0
    buffer_load_dwordx4 v2, s[52:55], s81 offen offset:0 lds
    buffer_load_dwordx4 v3, s[52:55], s81 offen offset:1024 lds
    buffer_load_dwordx4 v4, s[52:55], s81 offen offset:2048 lds
    buffer_load_dwordx4 v5, s[52:55], s81 offen offset:3072 lds
    s_add_u32 m0, s13, 40992
    s_add_u32 s81, s81, 128
    buffer_load_dwordx4 v6, s[56:59], s82 offen offset:0 lds
    buffer_load_dwordx4 v7, s[56:59], s82 offen offset:1024 lds
    buffer_load_dwordx4 v8, s[56:59], s82 offen offset:2048 lds
    s_add_u32 m0, s13, 53312
    s_nop 0
    buffer_load_dwordx4 v6, s[60:63], s82 offen offset:0 lds
    buffer_load_dwordx4 v7, s[60:63], s82 offen offset:1024 lds
    buffer_load_dwordx4 v8, s[60:63], s82 offen offset:2048 lds
    s_add_u32 s82, s82, 196608
    s_cmp_eq_u32 s82, 1966080
    s_cselect_b32 s82, 0, s82
    s_cselect_b32 s81, s6, s81
    v_and_b32 v12, 31, v0
    v_lshlrev_b32 v12, 4, v12
    s_add_u32 s9, s34, 496
    v_sub_u32 v10, s9, v12
    v_add_u32 v11, s34, v12
    v_and_b32 v12, 1, v0
    v_cmp_eq_u32 vcc, 1, v12
    v_lshlrev_b32 v33, 16, v33
    v_mov_b32 v128, 0
    v_mov_b32 v129, 0
    v_mov_b32 v130, 0
    v_mov_b32 v131, 0
    s_nop 0
    v_mul_f32 v192, v192, v37
    v_mul_f32 v193, v193, v37
    v_mul_f32 v194, v194, v37
    v_mul_f32 v195, v195, v37
    v_mul_f32 v196, v196, v37
    v_mul_f32 v197, v197, v37
    v_mul_f32 v198, v198, v37
    v_mul_f32 v199, v199, v37
    v_mul_f32 v200, v200, v37
    v_mul_f32 v201, v201, v37
    v_mul_f32 v202, v202, v37
    v_mul_f32 v203, v203, v37
    v_mul_f32 v204, v204, v37
    v_mul_f32 v205, v205, v37
    v_mul_f32 v206, v206, v37
    v_mul_f32 v207, v207, v37
    s_mov_b64 exec, 1
    v_add_f32 v192, v192, v33
    s_mov_b32 exec_lo, -1
    ds_write_b128 v11, v[128:131] offset:4096
    s_mov_b32 exec_hi, -1
    v_cvt_pk_bf16_f32 v132, v199, v198
    v_cvt_pk_bf16_f32 v133, v197, v196
    v_cvt_pk_bf16_f32 v134, v195, v194
    v_cvt_pk_bf16_f32 v135, v193, v192
    s_mov_b32 exec_hi, 0
    ds_write_b128 v10, v[132:135] offset:3584
    s_mov_b32 exec_hi, -1
    v_cvt_pk_bf16_f32 v136, v204, v203
    v_cvt_pk_bf16_f32 v137, v202, v202
    v_cvt_pk_bf16_f32 v138, v202, v201
    v_cvt_pk_bf16_f32 v139, v200, v200
    s_mov_b32 exec_hi, 0
    ds_write_b128 v10, v[136:139] offset:3072
    s_mov_b32 exec_hi, -1
    v_cvt_pk_bf16_f32 v140, v207, v207
    v_cvt_pk_bf16_f32 v141, v206, v206
    v_cvt_pk_bf16_f32 v142, v206, v205
    v_cvt_pk_bf16_f32 v143, v205, v205
    s_mov_b32 exec_hi, 0
    ds_write_b128 v10, v[140:143] offset:2560
    s_mov_b32 exec_hi, -1
    s_waitcnt vmcnt(10)
    s_barrier
    s_add_u32 m0, s12, 81984
    s_nop 0
    buffer_load_dwordx4 v2, s[52:55], s81 offen offset:0 lds
    buffer_load_dwordx4 v3, s[52:55], s81 offen offset:1024 lds
    buffer_load_dwordx4 v4, s[52:55], s81 offen offset:2048 lds
    buffer_load_dwordx4 v5, s[52:55], s81 offen offset:3072 lds
    s_add_u32 m0, s13, 81984
    s_add_u32 s81, s81, 128
    buffer_load_dwordx4 v6, s[56:59], s82 offen offset:0 lds
    buffer_load_dwordx4 v7, s[56:59], s82 offen offset:1024 lds
    buffer_load_dwordx4 v8, s[56:59], s82 offen offset:2048 lds
    s_add_u32 m0, s13, 94304
    s_nop 0
    buffer_load_dwordx4 v6, s[60:63], s82 offen offset:0 lds
    buffer_load_dwordx4 v7, s[60:63], s82 offen offset:1024 lds
    buffer_load_dwordx4 v8, s[60:63], s82 offen offset:2048 lds
    s_add_u32 s82, s82, 196608
    s_cmp_eq_u32 s82, 1966080
    s_cselect_b32 s82, 0, s82
    s_cselect_b32 s81, s6, s81
    v_cvt_pk_bf16_f32 v144, v194, v194
    v_cvt_pk_bf16_f32 v145, v193, v193
    v_cvt_pk_bf16_f32 v146, v193, v192
    v_cvt_pk_bf16_f32 v147, v192, v192
    s_mov_b32 exec_lo, 0
    ds_write_b128 v10, v[144:147] offset:2048
    s_mov_b32 exec_lo, -1
    v_cndmask_b32 v12, v195, v196, vcc
    v_cvt_pk_bf16_f32 v148, v196, v196
    v_cvt_pk_bf16_f32 v149, v196, v12
    v_cvt_pk_bf16_f32 v150, v195, v195
    v_cvt_pk_bf16_f32 v151, v195, v195
    s_mov_b32 exec_lo, 0
    ds_write_b128 v10, v[148:151] offset:1536
    s_mov_b32 exec_lo, -1
    v_cndmask_b32 v12, v197, v198, vcc
    v_cvt_pk_bf16_f32 v152, v198, v198
    v_cvt_pk_bf16_f32 v153, v198, v12
    v_cvt_pk_bf16_f32 v154, v197, v197
    v_cvt_pk_bf16_f32 v155, v197, v197
    s_mov_b32 exec_lo, 0
    ds_write_b128 v10, v[152:155] offset:1024
    s_mov_b32 exec_lo, -1
    v_cndmask_b32 v12, v199, v200, vcc
    v_cvt_pk_bf16_f32 v156, v200, v200
    v_cvt_pk_bf16_f32 v157, v200, v12
    v_cvt_pk_bf16_f32 v158, v199, v199
    v_cvt_pk_bf16_f32 v159, v199, v199
    s_mov_b32 exec_lo, 0
    ds_write_b128 v10, v[156:159] offset:512
    s_mov_b32 exec_lo, -1
    v_cndmask_b32 v12, v201, v202, vcc
    v_cvt_pk_bf16_f32 v160, v202, v202
    v_cvt_pk_bf16_f32 v161, v202, v12
    v_cvt_pk_bf16_f32 v162, v201, v201
    v_cvt_pk_bf16_f32 v163, v201, v201
    s_mov_b32 exec_lo, 0
    ds_write_b128 v10, v[160:163] offset:0
    s_mov_b32 exec_lo, -1
    s_waitcnt vmcnt(10)
    s_barrier
    s_add_u32 m0, s12, 0
    s_nop 0
    buffer_load_dwordx4 v2, s[52:55], s81 offen offset:0 lds
    buffer_load_dwordx4 v3, s[52:55], s81 offen offset:1024 lds
    buffer_load_dwordx4 v4, s[52:55], s81 offen offset:2048 lds
    buffer_load_dwordx4 v5, s[52:55], s81 offen offset:3072 lds
    s_add_u32 m0, s13, 0
    s_add_u32 s81, s81, 128
    buffer_load_dwordx4 v6, s[56:59], s82 offen offset:0 lds
    buffer_load_dwordx4 v7, s[56:59], s82 offen offset:1024 lds
    buffer_load_dwordx4 v8, s[56:59], s82 offen offset:2048 lds
    s_add_u32 m0, s13, 12320
    s_nop 0
    buffer_load_dwordx4 v6, s[60:63], s82 offen offset:0 lds
    buffer_load_dwordx4 v7, s[60:63], s82 offen offset:1024 lds
    buffer_load_dwordx4 v8, s[60:63], s82 offen offset:2048 lds
    s_add_u32 s82, s82, 196608
    s_cmp_eq_u32 s82, 1966080
    s_cselect_b32 s82, 0, s82
    s_cselect_b32 s81, s6, s81
    s_waitcnt vmcnt(10)
    s_barrier
    s_add_u32 m0, s12, 40992
    s_nop 0
    buffer_load_dwordx4 v2, s[52:55], s81 offen offset:0 lds
    buffer_load_dwordx4 v3, s[52:55], s81 offen offset:1024 lds
    buffer_load_dwordx4 v4, s[52:55], s81 offen offset:2048 lds
    buffer_load_dwordx4 v5, s[52:55], s81 offen offset:3072 lds
    s_add_u32 m0, s13, 40992
    s_add_u32 s81, s81, 128
    buffer_load_dwordx4 v6, s[56:59], s82 offen offset:0 lds
    buffer_load_dwordx4 v7, s[56:59], s82 offen offset:1024 lds
    buffer_load_dwordx4 v8, s[56:59], s82 offen offset:2048 lds
    s_add_u32 m0, s13, 53312
    s_nop 0
    buffer_load_dwordx4 v6, s[60:63], s82 offen offset:0 lds
    buffer_load_dwordx4 v7, s[60:63], s82 offen offset:1024 lds
    buffer_load_dwordx4 v8, s[60:63], s82 offen offset:2048 lds
    s_add_u32 s82, s82, 196608
    s_cmp_eq_u32 s82, 1966080
    s_cselect_b32 s82, 0, s82
    s_cselect_b32 s81, s6, s81
    s_waitcnt vmcnt(10)
    s_barrier
    s_add_u32 m0, s12, 81984
    s_nop 0
    buffer_load_dwordx4 v2, s[52:55], s81 offen offset:0 lds
    buffer_load_dwordx4 v3, s[52:55], s81 offen offset:1024 lds
    buffer_load_dwordx4 v4, s[52:55], s81 offen offset:2048 lds
    buffer_load_dwordx4 v5, s[52:55], s81 offen offset:3072 lds
    s_add_u32 m0, s13, 81984
    s_add_u32 s81, s81, 128
    buffer_load_dwordx4 v6, s[56:59], s82 offen offset:0 lds
    buffer_load_dwordx4 v7, s[56:59], s82 offen offset:1024 lds
    buffer_load_dwordx4 v8, s[56:59], s82 offen offset:2048 lds
    s_add_u32 m0, s13, 94304
    s_nop 0
    buffer_load_dwordx4 v6, s[60:63], s82 offen offset:0 lds
    buffer_load_dwordx4 v7, s[60:63], s82 offen offset:1024 lds
    buffer_load_dwordx4 v8, s[60:63], s82 offen offset:2048 lds
    s_add_u32 s82, s82, 196608
    s_cmp_eq_u32 s82, 1966080
    s_cselect_b32 s82, 0, s82
    s_cselect_b32 s81, s6, s81
    s_waitcnt vmcnt(10)
    s_barrier
    s_add_u32 m0, s12, 0
    s_nop 0
    buffer_load_dwordx4 v2, s[52:55], s81 offen offset:0 lds
    buffer_load_dwordx4 v3, s[52:55], s81 offen offset:1024 lds
    buffer_load_dwordx4 v4, s[52:55], s81 offen offset:2048 lds
    buffer_load_dwordx4 v5, s[52:55], s81 offen offset:3072 lds
    s_add_u32 m0, s13, 0
    s_add_u32 s81, s81, 128
    buffer_load_dwordx4 v6, s[56:59], s82 offen offset:0 lds
    buffer_load_dwordx4 v7, s[56:59], s82 offen offset:1024 lds
    buffer_load_dwordx4 v8, s[56:59], s82 offen offset:2048 lds
    s_add_u32 m0, s13, 12320
    s_nop 0
    buffer_load_dwordx4 v6, s[60:63], s82 offen offset:0 lds
    buffer_load_dwordx4 v7, s[60:63], s82 offen offset:1024 lds
    buffer_load_dwordx4 v8, s[60:63], s82 offen offset:2048 lds
    s_add_u32 s82, s82, 196608
    s_cmp_eq_u32 s82, 1966080
    s_cselect_b32 s82, 0, s82
    s_cselect_b32 s81, s6, s81
    s_waitcnt vmcnt(10)
    s_barrier
    s_add_u32 m0, s12, 40992
    s_nop 0
    buffer_load_dwordx4 v2, s[52:55], s81 offen offset:0 lds
    buffer_load_dwordx4 v3, s[52:55], s81 offen offset:1024 lds
    buffer_load_dwordx4 v4, s[52:55], s81 offen offset:2048 lds
    buffer_load_dwordx4 v5, s[52:55], s81 offen offset:3072 lds
    s_add_u32 m0, s13, 40992
    s_add_u32 s81, s81, 128
    buffer_load_dwordx4 v6, s[56:59], s82 offen offset:0 lds
    buffer_load_dwordx4 v7, s[56:59], s82 offen offset:1024 lds
    buffer_load_dwordx4 v8, s[56:59], s82 offen offset:2048 lds
    s_add_u32 m0, s13, 53312
    s_nop 0
    buffer_load_dwordx4 v6, s[60:63], s82 offen offset:0 lds
    buffer_load_dwordx4 v7, s[60:63], s82 offen offset:1024 lds
    buffer_load_dwordx4 v8, s[60:63], s82 offen offset:2048 lds
    s_add_u32 s82, s82, 196608
    s_cmp_eq_u32 s82, 1966080
    s_cselect_b32 s82, 0, s82
    s_cselect_b32 s81, s6, s81
    s_waitcnt vmcnt(10)
    s_barrier
    s_mul_i32 s50, s83, 4224
    v_lshlrev_b32 v9, 4, v0
    s_add_u32 m0, s35, 32
    s_add_u32 s51, s50, 6291578
    buffer_load_dwordx4 v9, s[68:71], s51 offen offset:0 sc1 lds
    buffer_load_dwordx4 v9, s[68:71], s51 offen offset:1024 sc1 lds
    buffer_load_dwordx4 v9, s[68:71], s51 offen offset:2048 sc1 lds
    buffer_load_dwordx4 v9, s[68:71], s51 offen offset:3072 sc1 lds
    s_add_u32 m0, s35, 4192
    s_add_u32 s51, s50, 6291580
    buffer_load_dwordx4 v9, s[68:71], s51 offen offset:0 sc1 lds
    buffer_load_dwordx4 v9, s[68:71], s51 offen offset:1024 sc1 lds
    buffer_load_dwordx4 v9, s[68:71], s51 offen offset:2048 sc1 lds
    buffer_load_dwordx4 v9, s[68:71], s51 offen offset:3072 sc1 lds
    s_add_u32 m0, s35, 8352
    s_add_u32 s51, s50, 6291582
    buffer_load_dwordx4 v9, s[68:71], s51 offen offset:0 sc1 lds
    buffer_load_dwordx4 v9, s[68:71], s51 offen offset:1024 sc1 lds
    buffer_load_dwordx4 v9, s[68:71], s51 offen offset:2048 sc1 lds
    buffer_load_dwordx4 v9, s[68:71], s51 offen offset:3072 sc1 lds
    s_waitcnt vmcnt(12)
    s_barrier
    s_add_u32 m0, s35, 12512
    s_add_u32 s51, s50, 6291584
    buffer_load_dwordx4 v9, s[68:71], s51 offen offset:0 sc1 lds
    buffer_load_dwordx4 v9, s[68:71], s51 offen offset:1024 sc1 lds
    buffer_load_dwordx4 v9, s[68:71], s51 offen offset:2048 sc1 lds
    buffer_load_dwordx4 v9, s[68:71], s51 offen offset:3072 sc1 lds
    v_and_b32 v5, 3, v0
    v_mul_u32_u24 v5, 4160, v5
    v_bfe_u32 v6, v0, 2, 2
    v_lshl_add_u32 v5, v6, 3, v5
    v_lshrrev_b32 v7, 4, v0
    v_lshl_add_u32 v5, v7, 4, v5
    s_add_u32 s9, s35, 8
    v_add_u32 v2, s9, v5
    v_and_b32 v8, 15, v0
    v_lshlrev_b32 v5, 5, v8
    v_lshlrev_b32 v6, 4, v7
    v_sub_u32 v6, v6, v5
    s_add_u32 s10, s34, 480
    v_add_u32 v3, s10, v6
    v_bfe_u32 v6, v0, 4, 1
    v_lshl_add_u32 v5, v6, 9, v5
    v_lshrrev_b32 v6, 5, v0
    v_lshl_add_u32 v4, v6, 4, v5
    v_mul_u32_u24 v5, 4160, v7
    v_lshl_add_u32 v5, v8, 1, v5
    v_add_u32 v5, s9, v5
    v_add_u32 v6, v7, v8
    v_cmp_gt_u32 vcc, 15, v6
    v_mov_b32 v32, 0
    v_mov_b32 v33, 0
    v_mov_b32 v34, 0
    v_mov_b32 v35, 0
    v_mov_b32 v36, 0
    v_mov_b32 v37, 0
    v_mov_b32 v38, 0
    v_mov_b32 v39, 0
    v_mov_b32 v40, 0
    v_mov_b32 v41, 0
    v_mov_b32 v42, 0
    v_mov_b32 v43, 0
    v_mov_b32 v44, 0
    v_mov_b32 v45, 0
    v_mov_b32 v46, 0
    v_mov_b32 v47, 0
    v_mov_b32 v48, 0
    v_mov_b32 v49, 0
    v_mov_b32 v50, 0
    v_mov_b32 v51, 0
    v_mov_b32 v52, 0
    v_mov_b32 v53, 0
    v_mov_b32 v54, 0
    v_mov_b32 v55, 0
    v_mov_b32 v56, 0
    v_mov_b32 v57, 0
    v_mov_b32 v58, 0
    v_mov_b32 v59, 0
    v_mov_b32 v60, 0
    v_mov_b32 v61, 0
    v_mov_b32 v62, 0
    v_mov_b32 v63, 0
    s_barrier
    s_add_u32 s50, s50, 9437184
    s_mov_b32 s15, 0
    s_setprio 2
    s_waitcnt vmcnt(0)
    s_mov_b64 exec, vcc
    ds_write_b16 v5, v32
    s_mov_b64 exec, -1
    ds_read_b128 v[96:99], v3 offset:3584
    ds_read_b64 v[64:65], v2 offset:0
    ds_read_b64 v[66:67], v2 offset:8
    ds_read_b128 v[100:103], v3 offset:3072
    ds_read_b64 v[68:69], v2 offset:512
    ds_read_b64 v[70:71], v2 offset:520
    ds_read_b128 v[104:107], v3 offset:2560
    ds_read_b64 v[72:73], v2 offset:1024
    ds_read_b64 v[74:75], v2 offset:1032
    ds_read_b128 v[108:111], v3 offset:2048
    ds_read_b64 v[76:77], v2 offset:1536
    ds_read_b64 v[78:79], v2 offset:1544
    ds_read_b128 v[112:115], v3 offset:1536
    ds_read_b64 v[80:81], v2 offset:2048
    ds_read_b64 v[82:83], v2 offset:2056
    ds_read_b128 v[116:119], v3 offset:1024
    ds_read_b64 v[84:85], v2 offset:2560
    ds_read_b64 v[86:87], v2 offset:2568
    ds_read_b128 v[120:123], v3 offset:512
    ds_read_b64 v[88:89], v2 offset:3072
    ds_read_b64 v[90:91], v2 offset:3080
    ds_read_b128 v[124:127], v3 offset:0
    ds_read_b64 v[92:93], v2 offset:3584
    ds_read_b64 v[94:95], v2 offset:3592
CV:
    s_waitcnt lgkmcnt(0)
    v_mfma_f32_16x16x32_bf16 v[60:63], v[64:67], v[124:127], v[60:63]
    ds_read_b128 v[160:163], v3 offset:3648
    v_mfma_f32_16x16x32_bf16 v[56:59], v[64:67], v[120:123], v[56:59]
    ds_read_b64 v[128:129], v2 offset:64
    v_mfma_f32_16x16x32_bf16 v[52:55], v[64:67], v[116:119], v[52:55]
    ds_read_b64 v[130:131], v2 offset:72
    v_mfma_f32_16x16x32_bf16 v[48:51], v[64:67], v[112:115], v[48:51]
    ds_read_b128 v[164:167], v3 offset:3136
    v_mfma_f32_16x16x32_bf16 v[60:63], v[68:71], v[120:123], v[60:63]
    ds_read_b64 v[132:133], v2 offset:576
    v_mfma_f32_16x16x32_bf16 v[56:59], v[68:71], v[116:119], v[56:59]
    ds_read_b64 v[134:135], v2 offset:584
    v_mfma_f32_16x16x32_bf16 v[52:55], v[68:71], v[112:115], v[52:55]
    ds_read_b128 v[168:171], v3 offset:2624
    v_mfma_f32_16x16x32_bf16 v[44:47], v[64:67], v[108:111], v[44:47]
    ds_read_b64 v[136:137], v2 offset:1088
    v_mfma_f32_16x16x32_bf16 v[60:63], v[72:75], v[116:119], v[60:63]
    ds_read_b64 v[138:139], v2 offset:1096
    v_mfma_f32_16x16x32_bf16 v[56:59], v[72:75], v[112:115], v[56:59]
    ds_read_b128 v[172:175], v3 offset:2112
    v_mfma_f32_16x16x32_bf16 v[48:51], v[68:71], v[108:111], v[48:51]
    ds_read_b64 v[140:141], v2 offset:1600
    v_mfma_f32_16x16x32_bf16 v[52:55], v[72:75], v[108:111], v[52:55]
    ds_read_b64 v[142:143], v2 offset:1608
    v_mfma_f32_16x16x32_bf16 v[60:63], v[76:79], v[112:115], v[60:63]
    ds_read_b128 v[176:179], v3 offset:1600
    v_mfma_f32_16x16x32_bf16 v[56:59], v[76:79], v[108:111], v[56:59]
    ds_read_b64 v[144:145], v2 offset:2112
    v_mfma_f32_16x16x32_bf16 v[40:43], v[64:67], v[104:107], v[40:43]
    ds_read_b64 v[146:147], v2 offset:2120
    v_mfma_f32_16x16x32_bf16 v[44:47], v[68:71], v[104:107], v[44:47]
    ds_read_b128 v[180:183], v3 offset:1088
    v_mfma_f32_16x16x32_bf16 v[60:63], v[80:83], v[108:111], v[60:63]
    ds_read_b64 v[148:149], v2 offset:2624
    v_mfma_f32_16x16x32_bf16 v[48:51], v[72:75], v[104:107], v[48:51]
    ds_read_b64 v[150:151], v2 offset:2632
    v_mfma_f32_16x16x32_bf16 v[52:55], v[76:79], v[104:107], v[52:55]
    ds_read_b128 v[184:187], v3 offset:576
    v_mfma_f32_16x16x32_bf16 v[56:59], v[80:83], v[104:107], v[56:59]
    ds_read_b64 v[152:153], v2 offset:3136
    v_mfma_f32_16x16x32_bf16 v[60:63], v[84:87], v[104:107], v[60:63]
    ds_read_b64 v[154:155], v2 offset:3144
    v_mfma_f32_16x16x32_bf16 v[36:39], v[64:67], v[100:103], v[36:39]
    ds_read_b128 v[188:191], v3 offset:64
    v_mfma_f32_16x16x32_bf16 v[40:43], v[68:71], v[100:103], v[40:43]
    ds_read_b64 v[156:157], v2 offset:3648
    v_mfma_f32_16x16x32_bf16 v[44:47], v[72:75], v[100:103], v[44:47]
    ds_read_b64 v[158:159], v2 offset:3656
    v_mfma_f32_16x16x32_bf16 v[48:51], v[76:79], v[100:103], v[48:51]
    v_mfma_f32_16x16x32_bf16 v[52:55], v[80:83], v[100:103], v[52:55]
    v_mfma_f32_16x16x32_bf16 v[56:59], v[84:87], v[100:103], v[56:59]
    v_add_u32 v2, 128, v2
    v_add_u32 v3, 128, v3
    v_mfma_f32_16x16x32_bf16 v[60:63], v[88:91], v[100:103], v[60:63]
    v_mfma_f32_16x16x32_bf16 v[32:35], v[64:67], v[96:99], v[32:35]
    v_mfma_f32_16x16x32_bf16 v[36:39], v[68:71], v[96:99], v[36:39]
    v_mfma_f32_16x16x32_bf16 v[40:43], v[72:75], v[96:99], v[40:43]
    v_mfma_f32_16x16x32_bf16 v[44:47], v[76:79], v[96:99], v[44:47]
    v_mfma_f32_16x16x32_bf16 v[48:51], v[80:83], v[96:99], v[48:51]
    v_mfma_f32_16x16x32_bf16 v[52:55], v[84:87], v[96:99], v[52:55]
    v_mfma_f32_16x16x32_bf16 v[56:59], v[88:91], v[96:99], v[56:59]
    v_mfma_f32_16x16x32_bf16 v[60:63], v[92:95], v[96:99], v[60:63]
    s_waitcnt lgkmcnt(0)
    v_mfma_f32_16x16x32_bf16 v[60:63], v[128:131], v[188:191], v[60:63]
    ds_read_b128 v[96:99], v3 offset:3584
    v_mfma_f32_16x16x32_bf16 v[56:59], v[128:131], v[184:187], v[56:59]
    ds_read_b64 v[64:65], v2 offset:0
    v_mfma_f32_16x16x32_bf16 v[52:55], v[128:131], v[180:183], v[52:55]
    ds_read_b64 v[66:67], v2 offset:8
    v_mfma_f32_16x16x32_bf16 v[48:51], v[128:131], v[176:179], v[48:51]
    ds_read_b128 v[100:103], v3 offset:3072
    v_mfma_f32_16x16x32_bf16 v[60:63], v[132:135], v[184:187], v[60:63]
    ds_read_b64 v[68:69], v2 offset:512
    v_mfma_f32_16x16x32_bf16 v[56:59], v[132:135], v[180:183], v[56:59]
    ds_read_b64 v[70:71], v2 offset:520
    v_mfma_f32_16x16x32_bf16 v[52:55], v[132:135], v[176:179], v[52:55]
    ds_read_b128 v[104:107], v3 offset:2560
    v_mfma_f32_16x16x32_bf16 v[44:47], v[128:131], v[172:175], v[44:47]
    ds_read_b64 v[72:73], v2 offset:1024
    v_mfma_f32_16x16x32_bf16 v[60:63], v[136:139], v[180:183], v[60:63]
    ds_read_b64 v[74:75], v2 offset:1032
    v_mfma_f32_16x16x32_bf16 v[56:59], v[136:139], v[176:179], v[56:59]
    ds_read_b128 v[108:111], v3 offset:2048
    v_mfma_f32_16x16x32_bf16 v[48:51], v[132:135], v[172:175], v[48:51]
    ds_read_b64 v[76:77], v2 offset:1536
    v_mfma_f32_16x16x32_bf16 v[52:55], v[136:139], v[172:175], v[52:55]
    ds_read_b64 v[78:79], v2 offset:1544
    v_mfma_f32_16x16x32_bf16 v[60:63], v[140:143], v[176:179], v[60:63]
    ds_read_b128 v[112:115], v3 offset:1536
    v_mfma_f32_16x16x32_bf16 v[56:59], v[140:143], v[172:175], v[56:59]
    ds_read_b64 v[80:81], v2 offset:2048
    v_mfma_f32_16x16x32_bf16 v[40:43], v[128:131], v[168:171], v[40:43]
    ds_read_b64 v[82:83], v2 offset:2056
    v_mfma_f32_16x16x32_bf16 v[44:47], v[132:135], v[168:171], v[44:47]
    ds_read_b128 v[116:119], v3 offset:1024
    v_mfma_f32_16x16x32_bf16 v[60:63], v[144:147], v[172:175], v[60:63]
    ds_read_b64 v[84:85], v2 offset:2560
    v_mfma_f32_16x16x32_bf16 v[48:51], v[136:139], v[168:171], v[48:51]
    ds_read_b64 v[86:87], v2 offset:2568
    v_mfma_f32_16x16x32_bf16 v[52:55], v[140:143], v[168:171], v[52:55]
    ds_read_b128 v[120:123], v3 offset:512
    v_mfma_f32_16x16x32_bf16 v[56:59], v[144:147], v[168:171], v[56:59]
    ds_read_b64 v[88:89], v2 offset:3072
    v_mfma_f32_16x16x32_bf16 v[60:63], v[148:151], v[168:171], v[60:63]
    ds_read_b64 v[90:91], v2 offset:3080
    v_mfma_f32_16x16x32_bf16 v[36:39], v[128:131], v[164:167], v[36:39]
    ds_read_b128 v[124:127], v3 offset:0
    v_mfma_f32_16x16x32_bf16 v[40:43], v[132:135], v[164:167], v[40:43]
    ds_read_b64 v[92:93], v2 offset:3584
    v_mfma_f32_16x16x32_bf16 v[44:47], v[136:139], v[164:167], v[44:47]
    ds_read_b64 v[94:95], v2 offset:3592
    v_mfma_f32_16x16x32_bf16 v[48:51], v[140:143], v[164:167], v[48:51]
    v_mfma_f32_16x16x32_bf16 v[52:55], v[144:147], v[164:167], v[52:55]
    v_mfma_f32_16x16x32_bf16 v[56:59], v[148:151], v[164:167], v[56:59]
    v_mfma_f32_16x16x32_bf16 v[60:63], v[152:155], v[164:167], v[60:63]
    v_mfma_f32_16x16x32_bf16 v[32:35], v[128:131], v[160:163], v[32:35]
    v_mfma_f32_16x16x32_bf16 v[36:39], v[132:135], v[160:163], v[36:39]
    v_mfma_f32_16x16x32_bf16 v[40:43], v[136:139], v[160:163], v[40:43]
    v_mfma_f32_16x16x32_bf16 v[44:47], v[140:143], v[160:163], v[44:47]
    v_mfma_f32_16x16x32_bf16 v[48:51], v[144:147], v[160:163], v[48:51]
    v_mfma_f32_16x16x32_bf16 v[52:55], v[148:151], v[160:163], v[52:55]
    v_mfma_f32_16x16x32_bf16 v[56:59], v[152:155], v[160:163], v[56:59]
    s_add_u32 s15, s15, 1
    s_cmp_lt_u32 s15, 4
    v_mfma_f32_16x16x32_bf16 v[60:63], v[156:159], v[160:163], v[60:63]
    s_cbranch_scc1 CV
    s_lshr_b32 s9, s83, 4
    s_lshl_b32 s9, s9, 7
    s_and_b32 s10, s83, 15
    s_lshl_b32 s10, s10, 0
    s_add_u32 s9, s9, s10
    s_add_u32 s9, s9, 12651776
    v_mov_b32 v5, s9
    v_mov_b32 v6, 1
    v_cvt_pk_bf16_f32 v10, v32, v33
    v_cvt_pk_bf16_f32 v11, v34, v35
    v_cvt_pk_bf16_f32 v12, v36, v37
    v_cvt_pk_bf16_f32 v13, v38, v39
    v_cvt_pk_bf16_f32 v14, v40, v41
    v_cvt_pk_bf16_f32 v15, v42, v43
    v_cvt_pk_bf16_f32 v16, v44, v45
    v_cvt_pk_bf16_f32 v17, v46, v47
    v_cvt_pk_bf16_f32 v18, v48, v49
    v_cvt_pk_bf16_f32 v19, v50, v51
    v_cvt_pk_bf16_f32 v20, v52, v53
    v_cvt_pk_bf16_f32 v21, v54, v55
    v_cvt_pk_bf16_f32 v22, v56, v57
    v_cvt_pk_bf16_f32 v23, v58, v59
    v_cvt_pk_bf16_f32 v24, v60, v61
    v_cvt_pk_bf16_f32 v25, v62, v63
    v_permlane16_swap_b32 v10, v12
    v_permlane16_swap_b32 v11, v13
    buffer_store_dwordx4 v[10:13], v4, s[68:71], s50 offen offset:0 sc1
    v_permlane16_swap_b32 v14, v16
    v_permlane16_swap_b32 v15, v17
    buffer_store_dwordx4 v[14:17], v4, s[68:71], s50 offen offset:1024 sc1
    v_permlane16_swap_b32 v18, v20
    v_permlane16_swap_b32 v19, v21
    buffer_store_dwordx4 v[18:21], v4, s[68:71], s50 offen offset:2048 sc1
    v_permlane16_swap_b32 v22, v24
    v_permlane16_swap_b32 v23, v25
    buffer_store_dwordx4 v[22:25], v4, s[68:71], s50 offen offset:3072 sc1
    s_waitcnt vmcnt(0)
    s_mov_b64 exec, 1
    buffer_store_byte v6, v5, s[68:71], 0 offen sc1
    s_endpgm
LOADONLY:
    s_and_b32 s14, s3, 3
    s_lshl_b32 s12, s14, 12
    s_mul_i32 s13, s14, 3072
    s_mul_i32 s6, s14, 40960
    s_add_u32 s13, s13, 16384
    s_mul_i32 s9, s4, 163840
    v_lshrrev_b32 v10, 3, v0
    v_mul_u32_u24 v10, 1280, v10
    v_add_u32 v10, s9, v10
    v_and_b32 v11, 7, v0
    v_lshrrev_b32 v12, 4, v0
    v_xor_b32 v11, v11, v12
    v_lshl_add_u32 v2, v11, 4, v10
    v_xor_b32 v11, 4, v11
    v_lshl_add_u32 v3, v11, 4, v10
    v_add_u32 v3, 9216, v3
    v_add_u32 v4, 18432, v2
    v_add_u32 v5, 18432, v3
    s_mov_b32 s76, 0x76543210
    s_mov_b32 s77, 0x78541298
    s_lshl_b32 s9, s5, 2
    s_lshr_b64 s[76:77], s[76:77], s9
    s_and_b32 s76, s76, 15
    s_add_u32 s9, s76, 2
    s_cmp_ge_u32 s9, 10
    s_cselect_b32 s10, 10, 0
    s_sub_u32 s9, s9, s10
    s_mul_i32 s82, s9, 196608
    s_lshl_b32 s9, s9, 7
    s_add_u32 s81, s9, s6
    s_mul_i32 s9, s14, 49152
    s_mul_i32 s10, s5, 192
    s_add_u32 s9, s9, s10
    v_add_u32 v10, 0, v0
    v_mul_u32_u24 v11, 171, v10
    v_lshrrev_b32 v11, 11, v11
    v_mul_u32_u24 v11, 2880, v11
    v_lshl_add_u32 v11, v0, 4, v11
    v_add_u32 v6, s9, v11
    v_add_u32 v10, 64, v0
    v_mul_u32_u24 v11, 171, v10
    v_lshrrev_b32 v11, 11, v11
    v_mul_u32_u24 v11, 2880, v11
    v_lshl_add_u32 v11, v0, 4, v11
    v_add_u32 v7, s9, v11
    v_add_u32 v10, 128, v0
    v_mul_u32_u24 v11, 171, v10
    v_lshrrev_b32 v11, 11, v11
    v_mul_u32_u24 v11, 2880, v11
    v_lshl_add_u32 v11, v0, 4, v11
    v_add_u32 v8, s9, v11
    s_waitcnt lgkmcnt(0)
    s_mov_b32 s52, s16
    s_mov_b32 s53, s17
    s_mov_b32 s54, 2621440
    s_mov_b32 s55, 0x20000
    s_mov_b32 s56, s36
    s_mov_b32 s57, s37
    s_mov_b32 s58, 1966080
    s_mov_b32 s59, 0x20000
    s_mov_b32 s60, s38
    s_mov_b32 s61, s39
    s_mov_b32 s62, 1966080
    s_mov_b32 s63, 0x20000
    s_mov_b32 s68, s48
    s_mov_b32 s69, s49
    s_mov_b32 s70, 15728640
    s_mov_b32 s71, 0x20000
    s_barrier
    s_add_u32 m0, s12, 0
    s_nop 0
    buffer_load_dwordx4 v2, s[52:55], s81 offen offset:0 lds
    buffer_load_dwordx4 v3, s[52:55], s81 offen offset:1024 lds
    buffer_load_dwordx4 v4, s[52:55], s81 offen offset:2048 lds
    buffer_load_dwordx4 v5, s[52:55], s81 offen offset:3072 lds
    s_add_u32 m0, s13, 0
    s_add_u32 s81, s81, 128
    buffer_load_dwordx4 v6, s[56:59], s82 offen offset:0 lds
    buffer_load_dwordx4 v7, s[56:59], s82 offen offset:1024 lds
    buffer_load_dwordx4 v8, s[56:59], s82 offen offset:2048 lds
    s_add_u32 m0, s13, 12320
    s_nop 0
    buffer_load_dwordx4 v6, s[60:63], s82 offen offset:0 lds
    buffer_load_dwordx4 v7, s[60:63], s82 offen offset:1024 lds
    buffer_load_dwordx4 v8, s[60:63], s82 offen offset:2048 lds
    s_add_u32 s82, s82, 196608
    s_cmp_eq_u32 s82, 1966080
    s_cselect_b32 s82, 0, s82
    s_cselect_b32 s81, s6, s81
    s_barrier
    s_add_u32 m0, s12, 40992
    s_nop 0
    buffer_load_dwordx4 v2, s[52:55], s81 offen offset:0 lds
    buffer_load_dwordx4 v3, s[52:55], s81 offen offset:1024 lds
    buffer_load_dwordx4 v4, s[52:55], s81 offen offset:2048 lds
    buffer_load_dwordx4 v5, s[52:55], s81 offen offset:3072 lds
    s_add_u32 m0, s13, 40992
    s_add_u32 s81, s81, 128
    buffer_load_dwordx4 v6, s[56:59], s82 offen offset:0 lds
    buffer_load_dwordx4 v7, s[56:59], s82 offen offset:1024 lds
    buffer_load_dwordx4 v8, s[56:59], s82 offen offset:2048 lds
    s_add_u32 m0, s13, 53312
    s_nop 0
    buffer_load_dwordx4 v6, s[60:63], s82 offen offset:0 lds
    buffer_load_dwordx4 v7, s[60:63], s82 offen offset:1024 lds
    buffer_load_dwordx4 v8, s[60:63], s82 offen offset:2048 lds
    s_add_u32 s82, s82, 196608
    s_cmp_eq_u32 s82, 1966080
    s_cselect_b32 s82, 0, s82
    s_cselect_b32 s81, s6, s81
    s_waitcnt vmcnt(10)
    s_barrier
    s_add_u32 m0, s12, 81984
    s_nop 0
    buffer_load_dwordx4 v2, s[52:55], s81 offen offset:0 lds
    buffer_load_dwordx4 v3, s[52:55], s81 offen offset:1024 lds
    buffer_load_dwordx4 v4, s[52:55], s81 offen offset:2048 lds
    buffer_load_dwordx4 v5, s[52:55], s81 offen offset:3072 lds
    s_add_u32 m0, s13, 81984
    s_add_u32 s81, s81, 128
    buffer_load_dwordx4 v6, s[56:59], s82 offen offset:0 lds
    buffer_load_dwordx4 v7, s[56:59], s82 offen offset:1024 lds
    buffer_load_dwordx4 v8, s[56:59], s82 offen offset:2048 lds
    s_add_u32 m0, s13, 94304
    s_nop 0
    buffer_load_dwordx4 v6, s[60:63], s82 offen offset:0 lds
    buffer_load_dwordx4 v7, s[60:63], s82 offen offset:1024 lds
    buffer_load_dwordx4 v8, s[60:63], s82 offen offset:2048 lds
    s_add_u32 s82, s82, 196608
    s_cmp_eq_u32 s82, 1966080
    s_cselect_b32 s82, 0, s82
    s_cselect_b32 s81, s6, s81
    s_lshr_b32 s9, s101, 1
    s_mul_i32 s77, s9, 3
    s_add_u32 s77, s77, 2
    s_lshr_b32 s10, s101, 5
    s_mul_i32 s9, s10, 48
    s_sub_u32 s9, s77, s9
    s_mul_i32 s9, s9, 40960
    s_mul_i32 s10, s10, 160
    s_add_u32 s78, s9, s10
    v_lshlrev_b32 v1, 4, v0
    v_add_u32 v9, 0, v0
    v_mul_u32_u24 v9, 6554, v9
    v_lshrrev_b32 v9, 16, v9
    v_mul_u32_u24 v9, 1120, v9
    v_add_u32 v200, v9, v1
    v_add_u32 v9, 64, v0
    v_mul_u32_u24 v9, 6554, v9
    v_lshrrev_b32 v9, 16, v9
    v_mul_u32_u24 v9, 1120, v9
    v_add_u32 v201, v9, v1
    v_add_u32 v9, 128, v0
    v_mul_u32_u24 v9, 6554, v9
    v_lshrrev_b32 v9, 16, v9
    v_mul_u32_u24 v9, 1120, v9
    v_add_u32 v202, v9, v1
    v_add_u32 v9, 192, v0
    v_mul_u32_u24 v9, 6554, v9
    v_lshrrev_b32 v9, 16, v9
    v_mul_u32_u24 v9, 1120, v9
    v_add_u32 v203, v9, v1
    v_add_u32 v9, 256, v0
    v_mul_u32_u24 v9, 6554, v9
    v_lshrrev_b32 v9, 16, v9
    v_mul_u32_u24 v9, 1120, v9
    v_add_u32 v204, v9, v1
    s_mov_b32 m0, 154624
    v_add_u32 v204, 4096, v204
    s_waitcnt lgkmcnt(0)
    s_mov_b32 s64, s40
    s_mov_b32 s65, s41
    s_mov_b32 s66, 1966080
    s_mov_b32 s67, 0x20000
    buffer_load_dwordx4 v200, s[64:67], s78 offen offset:0 lds
    buffer_load_dwordx4 v201, s[64:67], s78 offen offset:1024 lds
    buffer_load_dwordx4 v202, s[64:67], s78 offen offset:2048 lds
    buffer_load_dwordx4 v203, s[64:67], s78 offen offset:3072 lds
    s_mov_b32 m0, 158720
    s_nop 0
    buffer_load_dwordx4 v204, s[64:67], s78 offen offset:0 lds
    s_mul_i32 s78, s77, 5120
    s_add_u32 s78, s78, 13631488
    s_waitcnt vmcnt(15)
    s_barrier
    s_add_u32 m0, s12, 0
    s_nop 0
    buffer_load_dwordx4 v2, s[52:55], s81 offen offset:0 lds
    buffer_load_dwordx4 v3, s[52:55], s81 offen offset:1024 lds
    buffer_load_dwordx4 v4, s[52:55], s81 offen offset:2048 lds
    buffer_load_dwordx4 v5, s[52:55], s81 offen offset:3072 lds
    s_add_u32 m0, s13, 0
    s_add_u32 s81, s81, 128
    buffer_load_dwordx4 v6, s[56:59], s82 offen offset:0 lds
    buffer_load_dwordx4 v7, s[56:59], s82 offen offset:1024 lds
    buffer_load_dwordx4 v8, s[56:59], s82 offen offset:2048 lds
    s_add_u32 m0, s13, 12320
    s_nop 0
    buffer_load_dwordx4 v6, s[60:63], s82 offen offset:0 lds
    buffer_load_dwordx4 v7, s[60:63], s82 offen offset:1024 lds
    buffer_load_dwordx4 v8, s[60:63], s82 offen offset:2048 lds
    s_add_u32 s82, s82, 196608
    s_cmp_eq_u32 s82, 1966080
    s_cselect_b32 s82, 0, s82
    s_cselect_b32 s81, s6, s81
    s_waitcnt vmcnt(15)
    s_barrier
    s_add_u32 m0, s12, 40992
    s_nop 0
    buffer_load_dwordx4 v2, s[52:55], s81 offen offset:0 lds
    buffer_load_dwordx4 v3, s[52:55], s81 offen offset:1024 lds
    buffer_load_dwordx4 v4, s[52:55], s81 offen offset:2048 lds
    buffer_load_dwordx4 v5, s[52:55], s81 offen offset:3072 lds
    s_add_u32 m0, s13, 40992
    s_add_u32 s81, s81, 128
    buffer_load_dwordx4 v6, s[56:59], s82 offen offset:0 lds
    buffer_load_dwordx4 v7, s[56:59], s82 offen offset:1024 lds
    buffer_load_dwordx4 v8, s[56:59], s82 offen offset:2048 lds
    s_add_u32 m0, s13, 53312
    s_nop 0
    buffer_load_dwordx4 v6, s[60:63], s82 offen offset:0 lds
    buffer_load_dwordx4 v7, s[60:63], s82 offen offset:1024 lds
    buffer_load_dwordx4 v8, s[60:63], s82 offen offset:2048 lds
    s_add_u32 s82, s82, 196608
    s_cmp_eq_u32 s82, 1966080
    s_cselect_b32 s82, 0, s82
    s_cselect_b32 s81, s6, s81
    v_bfe_u32 v200, v0, 2, 2
    v_bfe_u32 v201, v0, 4, 1
    v_lshl_add_u32 v200, v201, 2, v200
    v_lshrrev_b32 v201, 5, v0
    v_lshl_add_u32 v200, v201, 4, v200
    v_mul_u32_u24 v200, 160, v200
    v_and_b32 v201, 3, v0
    v_mul_u32_u24 v201, 40, v201
    s_mov_b32 s9, 154624
    v_add3_u32 v206, v200, v201, s9
    v_add_u32 v201, 4096, v1
    s_waitcnt vmcnt(20)
    ds_read_b64_tr_b16 v[224:225], v206 offset:0
    ds_read_b64_tr_b16 v[226:227], v206 offset:1280
    ds_read_b64_tr_b16 v[228:229], v206 offset:8
    ds_read_b64_tr_b16 v[230:231], v206 offset:1288
    ds_read_b64_tr_b16 v[232:233], v206 offset:16
    ds_read_b64_tr_b16 v[234:235], v206 offset:1296
    ds_read_b64_tr_b16 v[236:237], v206 offset:24
    ds_read_b64_tr_b16 v[238:239], v206 offset:1304
    ds_read_b64_tr_b16 v[240:241], v206 offset:32
    ds_read_b64_tr_b16 v[242:243], v206 offset:1312
    s_waitcnt lgkmcnt(8)
    buffer_store_dwordx4 v[224:227], v1, s[68:71], s78 offen offset:0 sc1
    s_waitcnt lgkmcnt(6)
    buffer_store_dwordx4 v[228:231], v1, s[68:71], s78 offen offset:1024 sc1
    s_waitcnt lgkmcnt(4)
    buffer_store_dwordx4 v[232:235], v1, s[68:71], s78 offen offset:2048 sc1
    s_waitcnt lgkmcnt(2)
    buffer_store_dwordx4 v[236:239], v1, s[68:71], s78 offen offset:3072 sc1
    s_waitcnt lgkmcnt(0)
    buffer_store_dwordx4 v[240:243], v201, s[68:71], s78 offen offset:0 sc1
    s_waitcnt vmcnt(15)
    s_barrier
    s_add_u32 m0, s12, 81984
    s_nop 0
    buffer_load_dwordx4 v2, s[52:55], s81 offen offset:0 lds
    buffer_load_dwordx4 v3, s[52:55], s81 offen offset:1024 lds
    buffer_load_dwordx4 v4, s[52:55], s81 offen offset:2048 lds
    buffer_load_dwordx4 v5, s[52:55], s81 offen offset:3072 lds
    s_add_u32 m0, s13, 81984
    s_add_u32 s81, s81, 128
    buffer_load_dwordx4 v6, s[56:59], s82 offen offset:0 lds
    buffer_load_dwordx4 v7, s[56:59], s82 offen offset:1024 lds
    buffer_load_dwordx4 v8, s[56:59], s82 offen offset:2048 lds
    s_add_u32 m0, s13, 94304
    s_nop 0
    buffer_load_dwordx4 v6, s[60:63], s82 offen offset:0 lds
    buffer_load_dwordx4 v7, s[60:63], s82 offen offset:1024 lds
    buffer_load_dwordx4 v8, s[60:63], s82 offen offset:2048 lds
    s_add_u32 s82, s82, 196608
    s_cmp_eq_u32 s82, 1966080
    s_cselect_b32 s82, 0, s82
    s_cselect_b32 s81, s6, s81
    s_waitcnt vmcnt(15)
    s_waitcnt vmcnt(10)
    s_barrier
    s_add_u32 m0, s12, 0
    s_nop 0
    buffer_load_dwordx4 v2, s[52:55], s81 offen offset:0 lds
    buffer_load_dwordx4 v3, s[52:55], s81 offen offset:1024 lds
    buffer_load_dwordx4 v4, s[52:55], s81 offen offset:2048 lds
    buffer_load_dwordx4 v5, s[52:55], s81 offen offset:3072 lds
    s_add_u32 m0, s13, 0
    s_add_u32 s81, s81, 128
    buffer_load_dwordx4 v6, s[56:59], s82 offen offset:0 lds
    buffer_load_dwordx4 v7, s[56:59], s82 offen offset:1024 lds
    buffer_load_dwordx4 v8, s[56:59], s82 offen offset:2048 lds
    s_add_u32 m0, s13, 12320
    s_nop 0
    buffer_load_dwordx4 v6, s[60:63], s82 offen offset:0 lds
    buffer_load_dwordx4 v7, s[60:63], s82 offen offset:1024 lds
    buffer_load_dwordx4 v8, s[60:63], s82 offen offset:2048 lds
    s_add_u32 s82, s82, 196608
    s_cmp_eq_u32 s82, 1966080
    s_cselect_b32 s82, 0, s82
    s_cselect_b32 s81, s6, s81
    s_waitcnt vmcnt(10)
    s_barrier
    s_add_u32 m0, s12, 40992
    s_nop 0
    buffer_load_dwordx4 v2, s[52:55], s81 offen offset:0 lds
    buffer_load_dwordx4 v3, s[52:55], s81 offen offset:1024 lds
    buffer_load_dwordx4 v4, s[52:55], s81 offen offset:2048 lds
    buffer_load_dwordx4 v5, s[52:55], s81 offen offset:3072 lds
    s_add_u32 m0, s13, 40992
    s_add_u32 s81, s81, 128
    buffer_load_dwordx4 v6, s[56:59], s82 offen offset:0 lds
    buffer_load_dwordx4 v7, s[56:59], s82 offen offset:1024 lds
    buffer_load_dwordx4 v8, s[56:59], s82 offen offset:2048 lds
    s_add_u32 m0, s13, 53312
    s_nop 0
    buffer_load_dwordx4 v6, s[60:63], s82 offen offset:0 lds
    buffer_load_dwordx4 v7, s[60:63], s82 offen offset:1024 lds
    buffer_load_dwordx4 v8, s[60:63], s82 offen offset:2048 lds
    s_add_u32 s82, s82, 196608
    s_cmp_eq_u32 s82, 1966080
    s_cselect_b32 s82, 0, s82
    s_cselect_b32 s81, s6, s81
    s_waitcnt vmcnt(10)
    s_barrier
    s_waitcnt vmcnt(0)
    s_barrier
    s_endpgm
X3PATH:
    s_and_b32 s14, s3, 3
    s_lshl_b32 s12, s14, 12
    s_mul_i32 s13, s14, 3072
    s_mul_i32 s6, s14, 40960
    s_add_u32 s13, s13, 16384
    s_mul_i32 s9, s4, 163840
    v_lshrrev_b32 v10, 3, v0
    v_mul_u32_u24 v10, 1280, v10
    v_add_u32 v10, s9, v10
    v_and_b32 v11, 7, v0
    v_lshrrev_b32 v12, 4, v0
    v_xor_b32 v11, v11, v12
    v_lshl_add_u32 v2, v11, 4, v10
    v_xor_b32 v11, 4, v11
    v_lshl_add_u32 v3, v11, 4, v10
    v_add_u32 v3, 9216, v3
    v_add_u32 v4, 18432, v2
    v_add_u32 v5, 18432, v3
    s_mov_b32 s76, 0x76543210
    s_mov_b32 s77, 0x78541298
    s_lshl_b32 s9, s5, 2
    s_lshr_b64 s[76:77], s[76:77], s9
    s_and_b32 s76, s76, 15
    s_add_u32 s9, s76, 2
    s_cmp_ge_u32 s9, 10
    s_cselect_b32 s10, 10, 0
    s_sub_u32 s9, s9, s10
    s_mul_i32 s82, s9, 196608
    s_lshl_b32 s9, s9, 7
    s_add_u32 s81, s9, s6
    s_mul_i32 s9, s14, 49152
    s_mul_i32 s10, s5, 192
    s_add_u32 s9, s9, s10
    v_add_u32 v10, 0, v0
    v_mul_u32_u24 v11, 171, v10
    v_lshrrev_b32 v11, 11, v11
    v_mul_u32_u24 v11, 2880, v11
    v_lshl_add_u32 v11, v0, 4, v11
    v_add_u32 v6, s9, v11
    v_add_u32 v10, 64, v0
    v_mul_u32_u24 v11, 171, v10
    v_lshrrev_b32 v11, 11, v11
    v_mul_u32_u24 v11, 2880, v11
    v_lshl_add_u32 v11, v0, 4, v11
    v_add_u32 v7, s9, v11
    v_add_u32 v10, 128, v0
    v_mul_u32_u24 v11, 171, v10
    v_lshrrev_b32 v11, 11, v11
    v_mul_u32_u24 v11, 2880, v11
    v_lshl_add_u32 v11, v0, 4, v11
    v_add_u32 v8, s9, v11
    s_waitcnt lgkmcnt(0)
    s_mov_b32 s52, s16
    s_mov_b32 s53, s17
    s_mov_b32 s54, 2621440
    s_mov_b32 s55, 0x20000
    s_mov_b32 s56, s36
    s_mov_b32 s57, s37
    s_mov_b32 s58, 1966080
    s_mov_b32 s59, 0x20000
    s_mov_b32 s60, s38
    s_mov_b32 s61, s39
    s_mov_b32 s62, 1966080
    s_mov_b32 s63, 0x20000
    s_mov_b32 s68, s48
    s_mov_b32 s69, s49
    s_mov_b32 s70, 15728640
    s_mov_b32 s71, 0x20000
    s_mov_b32 s72, s42
    s_mov_b32 s73, s43
    s_mov_b32 s74, 1280
    s_mov_b32 s75, 0x20000
    v_lshlrev_b32 v9, 4, v0
    s_mov_b32 m0, 131968
    v_mov_b32 v28, 0
    v_mov_b32 v29, 0
    v_mov_b32 v30, 0
    v_mov_b32 v31, 0
    buffer_load_dwordx4 v9, s[72:75], 0 offen offset:0 lds
    buffer_load_dwordx4 v9, s[72:75], 0 offen offset:1024 lds
    s_cmp_eq_u32 s2, 0
    s_cbranch_scc0 NOINIT
    s_mov_b32 s9, 12648448
    buffer_store_dwordx4 v[28:31], v9, s[68:71], s9 offen offset:0 sc1
    buffer_store_dwordx4 v[28:31], v9, s[68:71], s9 offen offset:1024 sc1
    buffer_store_dwordx4 v[28:31], v9, s[68:71], s9 offen offset:2048 sc1
    buffer_store_dwordx4 v[28:31], v9, s[68:71], s9 offen offset:3072 sc1
    s_mov_b32 s9, 12652544
    buffer_store_dwordx4 v[28:31], v9, s[68:71], s9 offen offset:0 sc1
    buffer_store_dwordx4 v[28:31], v9, s[68:71], s9 offen offset:1024 sc1
    buffer_store_dwordx4 v[28:31], v9, s[68:71], s9 offen offset:2048 sc1
    buffer_store_dwordx4 v[28:31], v9, s[68:71], s9 offen offset:3072 sc1
    s_mov_b32 s9, 12656640
    buffer_store_dwordx4 v[28:31], v9, s[68:71], s9 offen offset:0 sc1
    buffer_store_dwordx4 v[28:31], v9, s[68:71], s9 offen offset:1024 sc1
    s_waitcnt vmcnt(0)
    v_mov_b32 v11, 1
    s_mov_b64 exec, 1
    global_store_dword v31, v11, s[46:47] sc1
    s_mov_b64 exec, -1
NOINIT:
    v_mov_b32 v10, 163328
    ds_write_b128 v10, v[28:31]
    ds_write_b128 v10, v[28:31] offset:16
    s_and_b32 s9, s5, 1
    s_lshl_b32 s9, s9, 2
    v_lshrrev_b32 v20, 4, v0
    v_add_u32 v21, s9, v20
    v_and_b32 v22, 7, v0
    v_xor_b32 v21, v21, v22
    v_lshrrev_b32 v18, 3, v0
    s_lshl_b32 s9, s5, 10
    v_lshlrev_b32 v23, 7, v18
    v_lshl_add_u32 v23, v21, 4, v23
    v_add_u32 v10, s9, v23
    v_add_u32 v11, 81984, v10
    v_lshlrev_b32 v12, 4, v22
    v_add_u32 v12, 131968, v12
    s_lshl_b32 s79, s76, 7
    s_waitcnt lgkmcnt(0)
    s_waitcnt vmcnt(0)
    s_barrier
    v_add_u32 v13, s79, v12
    ds_read_b128 v[20:23], v10 offset:40992
    ds_read_b128 v[24:27], v13
    s_add_u32 s79, s79, 128
    s_cmp_eq_u32 s79, 1280
    s_cselect_b32 s79, 0, s79
    s_add_u32 m0, s12, 0
    s_nop 0
    buffer_load_dwordx4 v2, s[52:55], s81 offen offset:0 lds
    buffer_load_dwordx4 v3, s[52:55], s81 offen offset:1024 lds
    buffer_load_dwordx4 v4, s[52:55], s81 offen offset:2048 lds
    buffer_load_dwordx4 v5, s[52:55], s81 offen offset:3072 lds
    s_add_u32 m0, s13, 0
    s_add_u32 s81, s81, 128
    buffer_load_dwordx4 v6, s[56:59], s82 offen offset:0 lds
    buffer_load_dwordx4 v7, s[56:59], s82 offen offset:1024 lds
    buffer_load_dwordx4 v8, s[56:59], s82 offen offset:2048 lds
    s_add_u32 m0, s13, 12320
    s_nop 0
    buffer_load_dwordx4 v6, s[60:63], s82 offen offset:0 lds
    buffer_load_dwordx4 v7, s[60:63], s82 offen offset:1024 lds
    buffer_load_dwordx4 v8, s[60:63], s82 offen offset:2048 lds
    s_add_u32 s82, s82, 196608
    s_cmp_eq_u32 s82, 1966080
    s_cselect_b32 s82, 0, s82
    s_cselect_b32 s81, s6, s81
    global_load_dword v32, v31, s[46:47] sc1
    s_waitcnt lgkmcnt(0)
    v_lshlrev_b32 v28, 16, v20
    v_lshlrev_b32 v29, 16, v24
    v_and_b32 v20, 0xffff0000, v20
    v_and_b32 v24, 0xffff0000, v24
    v_fmac_f32 v30, v28, v29
    v_fmac_f32 v30, v20, v24
    v_lshlrev_b32 v28, 16, v21
    v_lshlrev_b32 v29, 16, v25
    v_and_b32 v21, 0xffff0000, v21
    v_and_b32 v25, 0xffff0000, v25
    v_fmac_f32 v30, v28, v29
    v_fmac_f32 v30, v21, v25
    v_lshlrev_b32 v28, 16, v22
    v_lshlrev_b32 v29, 16, v26
    v_and_b32 v22, 0xffff0000, v22
    v_and_b32 v26, 0xffff0000, v26
    v_fmac_f32 v30, v28, v29
    v_fmac_f32 v30, v22, v26
    v_lshlrev_b32 v28, 16, v23
    v_lshlrev_b32 v29, 16, v27
    v_and_b32 v23, 0xffff0000, v23
    v_and_b32 v27, 0xffff0000, v27
    v_fmac_f32 v30, v28, v29
    v_fmac_f32 v30, v23, v27
    s_barrier
    v_add_u32 v13, s79, v12
    ds_read_b128 v[20:23], v11 offset:0
    ds_read_b128 v[24:27], v13
    s_add_u32 s79, s79, 128
    s_cmp_eq_u32 s79, 1280
    s_cselect_b32 s79, 0, s79
    s_add_u32 m0, s12, 40992
    s_nop 0
    buffer_load_dwordx4 v2, s[52:55], s81 offen offset:0 lds
    buffer_load_dwordx4 v3, s[52:55], s81 offen offset:1024 lds
    buffer_load_dwordx4 v4, s[52:55], s81 offen offset:2048 lds
    buffer_load_dwordx4 v5, s[52:55], s81 offen offset:3072 lds
    s_add_u32 m0, s13, 40992
    s_add_u32 s81, s81, 128
    buffer_load_dwordx4 v6, s[56:59], s82 offen offset:0 lds
    buffer_load_dwordx4 v7, s[56:59], s82 offen offset:1024 lds
    buffer_load_dwordx4 v8, s[56:59], s82 offen offset:2048 lds
    s_add_u32 m0, s13, 53312
    s_nop 0
    buffer_load_dwordx4 v6, s[60:63], s82 offen offset:0 lds
    buffer_load_dwordx4 v7, s[60:63], s82 offen offset:1024 lds
    buffer_load_dwordx4 v8, s[60:63], s82 offen offset:2048 lds
    s_add_u32 s82, s82, 196608
    s_cmp_eq_u32 s82, 1966080
    s_cselect_b32 s82, 0, s82
    s_cselect_b32 s81, s6, s81
    s_waitcnt lgkmcnt(0)
    v_lshlrev_b32 v28, 16, v20
    v_lshlrev_b32 v29, 16, v24
    v_and_b32 v20, 0xffff0000, v20
    v_and_b32 v24, 0xffff0000, v24
    v_fmac_f32 v30, v28, v29
    v_fmac_f32 v30, v20, v24
    v_lshlrev_b32 v28, 16, v21
    v_lshlrev_b32 v29, 16, v25
    v_and_b32 v21, 0xffff0000, v21
    v_and_b32 v25, 0xffff0000, v25
    v_fmac_f32 v30, v28, v29
    v_fmac_f32 v30, v21, v25
    v_lshlrev_b32 v28, 16, v22
    v_lshlrev_b32 v29, 16, v26
    v_and_b32 v22, 0xffff0000, v22
    v_and_b32 v26, 0xffff0000, v26
    v_fmac_f32 v30, v28, v29
    v_fmac_f32 v30, v22, v26
    v_lshlrev_b32 v28, 16, v23
    v_lshlrev_b32 v29, 16, v27
    v_and_b32 v23, 0xffff0000, v23
    v_and_b32 v27, 0xffff0000, v27
    v_fmac_f32 v30, v28, v29
    v_fmac_f32 v30, v23, v27
    s_waitcnt vmcnt(11)
    s_barrier
    v_add_u32 v13, s79, v12
    ds_read_b128 v[20:23], v10 offset:0
    ds_read_b128 v[24:27], v13
    s_add_u32 s79, s79, 128
    s_cmp_eq_u32 s79, 1280
    s_cselect_b32 s79, 0, s79
    s_waitcnt vmcnt(10)
    v_readfirstlane_b32 s9, v32
    s_nop 0
    s_cmp_eq_u32 s9, 1
    s_cbranch_scc1 GOOK
    s_mov_b32 s15, 0
SP_1:
    global_load_dword v32, v31, s[46:47] sc1
    s_waitcnt vmcnt(0)
    v_cmp_eq_u32 vcc, 1, v32
    s_add_u32 s15, s15, 1
    s_cmp_gt_u32 s15, 20000
    s_cbranch_scc1 SX_2
    s_cmp_eq_u64 vcc, -1
    s_cbranch_scc0 SP_1
SX_2:
GOOK:
    s_lshl_b32 s9, s76, 7
    s_lshl_b32 s10, s4, 2
    s_add_u32 s9, s9, s10
    s_add_u32 s9, s9, 12648448
    s_bitcmp1_b32 0x877b, s5
    s_cselect_b32 s9, s9, 0x40000000
    s_lshl_b32 s10, s101, 2
    s_add_u32 s10, s10, 12656896
    v_mov_b32 v19, s9
    s_mov_b64 exec, 1
    v_mov_b32 v19, s10
    s_mov_b64 exec, 2
    buffer_store_dword v32, v19, s[68:71], 0 offen sc1
    s_mov_b64 exec, -1
    s_add_u32 m0, s12, 81984
    s_nop 0
    buffer_load_dwordx4 v2, s[52:55], s81 offen offset:0 lds
    buffer_load_dwordx4 v3, s[52:55], s81 offen offset:1024 lds
    buffer_load_dwordx4 v4, s[52:55], s81 offen offset:2048 lds
    buffer_load_dwordx4 v5, s[52:55], s81 offen offset:3072 lds
    s_add_u32 m0, s13, 81984
    s_add_u32 s81, s81, 128
    buffer_load_dwordx4 v6, s[56:59], s82 offen offset:0 lds
    buffer_load_dwordx4 v7, s[56:59], s82 offen offset:1024 lds
    buffer_load_dwordx4 v8, s[56:59], s82 offen offset:2048 lds
    s_add_u32 m0, s13, 94304
    s_nop 0
    buffer_load_dwordx4 v6, s[60:63], s82 offen offset:0 lds
    buffer_load_dwordx4 v7, s[60:63], s82 offen offset:1024 lds
    buffer_load_dwordx4 v8, s[60:63], s82 offen offset:2048 lds
    s_add_u32 s82, s82, 196608
    s_cmp_eq_u32 s82, 1966080
    s_cselect_b32 s82, 0, s82
    s_cselect_b32 s81, s6, s81
    s_lshr_b32 s9, s101, 1
    s_mul_i32 s77, s9, 3
    s_and_b32 s9, s101, 1
    s_add_u32 s77, s77, s9
    s_lshr_b32 s10, s101, 5
    s_mul_i32 s9, s10, 48
    s_sub_u32 s9, s77, s9
    s_mul_i32 s9, s9, 40960
    s_mul_i32 s10, s10, 160
    s_add_u32 s78, s9, s10
    v_lshlrev_b32 v1, 4, v0
    v_add_u32 v9, 0, v0
    v_mul_u32_u24 v9, 6554, v9
    v_lshrrev_b32 v9, 16, v9
    v_mul_u32_u24 v9, 1120, v9
    v_add_u32 v200, v9, v1
    v_add_u32 v9, 64, v0
    v_mul_u32_u24 v9, 6554, v9
    v_lshrrev_b32 v9, 16, v9
    v_mul_u32_u24 v9, 1120, v9
    v_add_u32 v201, v9, v1
    v_add_u32 v9, 128, v0
    v_mul_u32_u24 v9, 6554, v9
    v_lshrrev_b32 v9, 16, v9
    v_mul_u32_u24 v9, 1120, v9
    v_add_u32 v202, v9, v1
    v_add_u32 v9, 192, v0
    v_mul_u32_u24 v9, 6554, v9
    v_lshrrev_b32 v9, 16, v9
    v_mul_u32_u24 v9, 1120, v9
    v_add_u32 v203, v9, v1
    v_add_u32 v9, 256, v0
    v_mul_u32_u24 v9, 6554, v9
    v_lshrrev_b32 v9, 16, v9
    v_mul_u32_u24 v9, 1120, v9
    v_add_u32 v204, v9, v1
    s_mov_b32 m0, 122976
    v_add_u32 v204, 4096, v204
    s_waitcnt lgkmcnt(0)
    s_mov_b32 s64, s40
    s_mov_b32 s65, s41
    s_mov_b32 s66, 1966080
    s_mov_b32 s67, 0x20000
    buffer_load_dwordx4 v200, s[64:67], s78 offen offset:0 lds
    buffer_load_dwordx4 v201, s[64:67], s78 offen offset:1024 lds
    buffer_load_dwordx4 v202, s[64:67], s78 offen offset:2048 lds
    buffer_load_dwordx4 v203, s[64:67], s78 offen offset:3072 lds
    s_mov_b32 m0, 127072
    s_nop 0
    buffer_load_dwordx4 v204, s[64:67], s78 offen offset:0 lds
    s_mul_i32 s78, s77, 5120
    s_add_u32 s78, s78, 13631488
    s_waitcnt lgkmcnt(0)
    v_lshlrev_b32 v28, 16, v20
    v_lshlrev_b32 v29, 16, v24
    v_and_b32 v20, 0xffff0000, v20
    v_and_b32 v24, 0xffff0000, v24
    v_fmac_f32 v30, v28, v29
    v_fmac_f32 v30, v20, v24
    v_lshlrev_b32 v28, 16, v21
    v_lshlrev_b32 v29, 16, v25
    v_and_b32 v21, 0xffff0000, v21
    v_and_b32 v25, 0xffff0000, v25
    v_fmac_f32 v30, v28, v29
    v_fmac_f32 v30, v21, v25
    v_lshlrev_b32 v28, 16, v22
    v_lshlrev_b32 v29, 16, v26
    v_and_b32 v22, 0xffff0000, v22
    v_and_b32 v26, 0xffff0000, v26
    v_fmac_f32 v30, v28, v29
    v_fmac_f32 v30, v22, v26
    v_lshlrev_b32 v28, 16, v23
    v_lshlrev_b32 v29, 16, v27
    v_and_b32 v23, 0xffff0000, v23
    v_and_b32 v27, 0xffff0000, v27
    v_fmac_f32 v30, v28, v29
    v_fmac_f32 v30, v23, v27
    s_waitcnt vmcnt(16)
    s_barrier
    v_add_u32 v13, s79, v12
    ds_read_b128 v[20:23], v10 offset:40992
    ds_read_b128 v[24:27], v13
    s_add_u32 s79, s79, 128
    s_cmp_eq_u32 s79, 1280
    s_cselect_b32 s79, 0, s79
    s_add_u32 m0, s12, 0
    s_nop 0
    buffer_load_dwordx4 v2, s[52:55], s81 offen offset:0 lds
    buffer_load_dwordx4 v3, s[52:55], s81 offen offset:1024 lds
    buffer_load_dwordx4 v4, s[52:55], s81 offen offset:2048 lds
    buffer_load_dwordx4 v5, s[52:55], s81 offen offset:3072 lds
    s_add_u32 m0, s13, 0
    s_add_u32 s81, s81, 128
    buffer_load_dwordx4 v6, s[56:59], s82 offen offset:0 lds
    buffer_load_dwordx4 v7, s[56:59], s82 offen offset:1024 lds
    buffer_load_dwordx4 v8, s[56:59], s82 offen offset:2048 lds
    s_add_u32 m0, s13, 12320
    s_nop 0
    buffer_load_dwordx4 v6, s[60:63], s82 offen offset:0 lds
    buffer_load_dwordx4 v7, s[60:63], s82 offen offset:1024 lds
    buffer_load_dwordx4 v8, s[60:63], s82 offen offset:2048 lds
    s_add_u32 s82, s82, 196608
    s_cmp_eq_u32 s82, 1966080
    s_cselect_b32 s82, 0, s82
    s_cselect_b32 s81, s6, s81
    s_waitcnt lgkmcnt(0)
    v_lshlrev_b32 v28, 16, v20
    v_lshlrev_b32 v29, 16, v24
    v_and_b32 v20, 0xffff0000, v20
    v_and_b32 v24, 0xffff0000, v24
    v_fmac_f32 v30, v28, v29
    v_fmac_f32 v30, v20, v24
    v_lshlrev_b32 v28, 16, v21
    v_lshlrev_b32 v29, 16, v25
    v_and_b32 v21, 0xffff0000, v21
    v_and_b32 v25, 0xffff0000, v25
    v_fmac_f32 v30, v28, v29
    v_fmac_f32 v30, v21, v25
    v_lshlrev_b32 v28, 16, v22
    v_lshlrev_b32 v29, 16, v26
    v_and_b32 v22, 0xffff0000, v22
    v_and_b32 v26, 0xffff0000, v26
    v_fmac_f32 v30, v28, v29
    v_fmac_f32 v30, v22, v26
    v_lshlrev_b32 v28, 16, v23
    v_lshlrev_b32 v29, 16, v27
    v_and_b32 v23, 0xffff0000, v23
    v_and_b32 v27, 0xffff0000, v27
    v_fmac_f32 v30, v28, v29
    v_fmac_f32 v30, v23, v27
    s_waitcnt vmcnt(15)
    s_barrier
    v_add_u32 v13, s79, v12
    ds_read_b128 v[20:23], v11 offset:0
    ds_read_b128 v[24:27], v13
    s_add_u32 s79, s79, 128
    s_cmp_eq_u32 s79, 1280
    s_cselect_b32 s79, 0, s79
    s_add_u32 m0, s12, 40992
    s_nop 0
    buffer_load_dwordx4 v2, s[52:55], s81 offen offset:0 lds
    buffer_load_dwordx4 v3, s[52:55], s81 offen offset:1024 lds
    buffer_load_dwordx4 v4, s[52:55], s81 offen offset:2048 lds
    buffer_load_dwordx4 v5, s[52:55], s81 offen offset:3072 lds
    s_add_u32 m0, s13, 40992
    s_add_u32 s81, s81, 128
    buffer_load_dwordx4 v6, s[56:59], s82 offen offset:0 lds
    buffer_load_dwordx4 v7, s[56:59], s82 offen offset:1024 lds
    buffer_load_dwordx4 v8, s[56:59], s82 offen offset:2048 lds
    s_add_u32 m0, s13, 53312
    s_nop 0
    buffer_load_dwordx4 v6, s[60:63], s82 offen offset:0 lds
    buffer_load_dwordx4 v7, s[60:63], s82 offen offset:1024 lds
    buffer_load_dwordx4 v8, s[60:63], s82 offen offset:2048 lds
    s_add_u32 s82, s82, 196608
    s_cmp_eq_u32 s82, 1966080
    s_cselect_b32 s82, 0, s82
    s_cselect_b32 s81, s6, s81
    v_bfe_u32 v200, v0, 2, 2
    v_bfe_u32 v201, v0, 4, 1
    v_lshl_add_u32 v200, v201, 2, v200
    v_lshrrev_b32 v201, 5, v0
    v_lshl_add_u32 v200, v201, 4, v200
    v_mul_u32_u24 v200, 160, v200
    v_and_b32 v201, 3, v0
    v_mul_u32_u24 v201, 40, v201
    s_mov_b32 s9, 122976
    v_add3_u32 v206, v200, v201, s9
    v_add_u32 v201, 4096, v1
    s_waitcnt vmcnt(20)
    ds_read_b64_tr_b16 v[224:225], v206 offset:0
    ds_read_b64_tr_b16 v[226:227], v206 offset:1280
    ds_read_b64_tr_b16 v[228:229], v206 offset:8
    ds_read_b64_tr_b16 v[230:231], v206 offset:1288
    ds_read_b64_tr_b16 v[232:233], v206 offset:16
    ds_read_b64_tr_b16 v[234:235], v206 offset:1296
    ds_read_b64_tr_b16 v[236:237], v206 offset:24
    ds_read_b64_tr_b16 v[238:239], v206 offset:1304
    ds_read_b64_tr_b16 v[240:241], v206 offset:32
    ds_read_b64_tr_b16 v[242:243], v206 offset:1312
    s_waitcnt lgkmcnt(8)
    buffer_store_dwordx4 v[224:227], v1, s[68:71], s78 offen offset:0 sc1
    s_waitcnt lgkmcnt(6)
    buffer_store_dwordx4 v[228:231], v1, s[68:71], s78 offen offset:1024 sc1
    s_waitcnt lgkmcnt(4)
    buffer_store_dwordx4 v[232:235], v1, s[68:71], s78 offen offset:2048 sc1
    s_waitcnt lgkmcnt(2)
    buffer_store_dwordx4 v[236:239], v1, s[68:71], s78 offen offset:3072 sc1
    s_waitcnt lgkmcnt(0)
    buffer_store_dwordx4 v[240:243], v201, s[68:71], s78 offen offset:0 sc1
    s_waitcnt lgkmcnt(0)
    v_lshlrev_b32 v28, 16, v20
    v_lshlrev_b32 v29, 16, v24
    v_and_b32 v20, 0xffff0000, v20
    v_and_b32 v24, 0xffff0000, v24
    v_fmac_f32 v30, v28, v29
    v_fmac_f32 v30, v20, v24
    v_lshlrev_b32 v28, 16, v21
    v_lshlrev_b32 v29, 16, v25
    v_and_b32 v21, 0xffff0000, v21
    v_and_b32 v25, 0xffff0000, v25
    v_fmac_f32 v30, v28, v29
    v_fmac_f32 v30, v21, v25
    v_lshlrev_b32 v28, 16, v22
    v_lshlrev_b32 v29, 16, v26
    v_and_b32 v22, 0xffff0000, v22
    v_and_b32 v26, 0xffff0000, v26
    v_fmac_f32 v30, v28, v29
    v_fmac_f32 v30, v22, v26
    v_lshlrev_b32 v28, 16, v23
    v_lshlrev_b32 v29, 16, v27
    v_and_b32 v23, 0xffff0000, v23
    v_and_b32 v27, 0xffff0000, v27
    v_fmac_f32 v30, v28, v29
    v_fmac_f32 v30, v23, v27
    s_waitcnt vmcnt(15)
    s_barrier
    v_add_u32 v13, s79, v12
    ds_read_b128 v[20:23], v10 offset:0
    ds_read_b128 v[24:27], v13
    s_add_u32 s79, s79, 128
    s_cmp_eq_u32 s79, 1280
    s_cselect_b32 s79, 0, s79
    s_add_u32 m0, s12, 81984
    s_nop 0
    buffer_load_dwordx4 v2, s[52:55], s81 offen offset:0 lds
    buffer_load_dwordx4 v3, s[52:55], s81 offen offset:1024 lds
    buffer_load_dwordx4 v4, s[52:55], s81 offen offset:2048 lds
    buffer_load_dwordx4 v5, s[52:55], s81 offen offset:3072 lds
    s_add_u32 m0, s13, 81984
    s_add_u32 s81, s81, 128
    buffer_load_dwordx4 v6, s[56:59], s82 offen offset:0 lds
    buffer_load_dwordx4 v7, s[56:59], s82 offen offset:1024 lds
    buffer_load_dwordx4 v8, s[56:59], s82 offen offset:2048 lds
    s_add_u32 m0, s13, 94304
    s_nop 0
    buffer_load_dwordx4 v6, s[60:63], s82 offen offset:0 lds
    buffer_load_dwordx4 v7, s[60:63], s82 offen offset:1024 lds
    buffer_load_dwordx4 v8, s[60:63], s82 offen offset:2048 lds
    s_add_u32 s82, s82, 196608
    s_cmp_eq_u32 s82, 1966080
    s_cselect_b32 s82, 0, s82
    s_cselect_b32 s81, s6, s81
    s_lshr_b32 s10, s101, 1
    s_mul_i32 s10, s10, 5
    s_and_b32 s9, s101, 1
    s_mul_i32 s11, s9, 3
    s_add_u32 s10, s10, s11
    s_add_u32 s11, s10, 2
    s_sub_u32 s11, s11, s9
    s_mul_i32 s9, s9, 33
    s_sub_u32 s9, 34, s9
    v_min_u32 v39, s9, v0
    s_mul_i32 s9, s10, 4224
    s_add_u32 s9, s9, 6291584
    v_lshl_add_u32 v38, v0, 7, s9
    v_lshl_add_u32 v39, v39, 7, s9
    v_add_u32 v39, 8192, v39
    s_lshr_b32 s10, s10, 6
    s_lshr_b32 s11, s11, 6
    s_sub_u32 s11, s11, s10
    s_lshl_b32 s11, s11, 7
    s_lshl_b32 s10, s10, 7
    s_add_u32 s10, s10, 12648448
    v_bfe_u32 v33, v0, 4, 1
    v_mul_u32_u24 v33, s11, v33
    v_and_b32 v34, 15, v0
    v_lshl_add_u32 v33, v34, 2, v33
    v_add_u32 v33, s10, v33
    buffer_load_dword v36, v33, s[68:71], 0 offen sc1
    s_waitcnt lgkmcnt(0)
    v_lshlrev_b32 v28, 16, v20
    v_lshlrev_b32 v29, 16, v24
    v_and_b32 v20, 0xffff0000, v20
    v_and_b32 v24, 0xffff0000, v24
    v_fmac_f32 v30, v28, v29
    v_fmac_f32 v30, v20, v24
    v_lshlrev_b32 v28, 16, v21
    v_lshlrev_b32 v29, 16, v25
    v_and_b32 v21, 0xffff0000, v21
    v_and_b32 v25, 0xffff0000, v25
    v_fmac_f32 v30, v28, v29
    v_fmac_f32 v30, v21, v25
    v_lshlrev_b32 v28, 16, v22
    v_lshlrev_b32 v29, 16, v26
    v_and_b32 v22, 0xffff0000, v22
    v_and_b32 v26, 0xffff0000, v26
    v_fmac_f32 v30, v28, v29
    v_fmac_f32 v30, v22, v26
    v_lshlrev_b32 v28, 16, v23
    v_lshlrev_b32 v29, 16, v27
    v_and_b32 v23, 0xffff0000, v23
    v_and_b32 v27, 0xffff0000, v27
    v_fmac_f32 v30, v28, v29
    v_fmac_f32 v30, v23, v27
    s_waitcnt vmcnt(16)
    s_waitcnt vmcnt(11)
    s_barrier
    v_add_u32 v13, s79, v12
    ds_read_b128 v[20:23], v10 offset:40992
    ds_read_b128 v[24:27], v13
    s_add_u32 s79, s79, 128
    s_cmp_eq_u32 s79, 1280
    s_cselect_b32 s79, 0, s79
    s_mov_b64 exec, 1
    buffer_store_dword v32, v19, s[68:71], 0 offen sc1
    s_mov_b64 exec, -1
    s_add_u32 m0, s12, 0
    s_nop 0
    buffer_load_dwordx4 v2, s[52:55], s81 offen offset:0 lds
    buffer_load_dwordx4 v3, s[52:55], s81 offen offset:1024 lds
    buffer_load_dwordx4 v4, s[52:55], s81 offen offset:2048 lds
    buffer_load_dwordx4 v5, s[52:55], s81 offen offset:3072 lds
    s_add_u32 m0, s13, 0
    s_add_u32 s81, s81, 128
    buffer_load_dwordx4 v6, s[56:59], s82 offen offset:0 lds
    buffer_load_dwordx4 v7, s[56:59], s82 offen offset:1024 lds
    buffer_load_dwordx4 v8, s[56:59], s82 offen offset:2048 lds
    s_add_u32 m0, s13, 12320
    s_nop 0
    buffer_load_dwordx4 v6, s[60:63], s82 offen offset:0 lds
    buffer_load_dwordx4 v7, s[60:63], s82 offen offset:1024 lds
    buffer_load_dwordx4 v8, s[60:63], s82 offen offset:2048 lds
    s_add_u32 s82, s82, 196608
    s_cmp_eq_u32 s82, 1966080
    s_cselect_b32 s82, 0, s82
    s_cselect_b32 s81, s6, s81
    s_waitcnt lgkmcnt(0)
    v_lshlrev_b32 v28, 16, v20
    v_lshlrev_b32 v29, 16, v24
    v_and_b32 v20, 0xffff0000, v20
    v_and_b32 v24, 0xffff0000, v24
    v_fmac_f32 v30, v28, v29
    v_fmac_f32 v30, v20, v24
    v_lshlrev_b32 v28, 16, v21
    v_lshlrev_b32 v29, 16, v25
    v_and_b32 v21, 0xffff0000, v21
    v_and_b32 v25, 0xffff0000, v25
    v_fmac_f32 v30, v28, v29
    v_fmac_f32 v30, v21, v25
    v_lshlrev_b32 v28, 16, v22
    v_lshlrev_b32 v29, 16, v26
    v_and_b32 v22, 0xffff0000, v22
    v_and_b32 v26, 0xffff0000, v26
    v_fmac_f32 v30, v28, v29
    v_fmac_f32 v30, v22, v26
    v_lshlrev_b32 v28, 16, v23
    v_lshlrev_b32 v29, 16, v27
    v_and_b32 v23, 0xffff0000, v23
    v_and_b32 v27, 0xffff0000, v27
    v_fmac_f32 v30, v28, v29
    v_fmac_f32 v30, v23, v27
    s_waitcnt vmcnt(12)
    s_waitcnt vmcnt(11)
    v_cmp_eq_u32 vcc, 1, v36
    s_nop 0
    s_cmp_eq_u64 vcc, -1
    s_cbranch_scc1 UFOK
    s_mov_b32 s15, 0
SP_3:
    buffer_load_dword v36, v33, s[68:71], 0 offen sc1
    s_waitcnt vmcnt(0)
    v_cmp_eq_u32 vcc, 1, v36
    s_add_u32 s15, s15, 1
    s_cmp_gt_u32 s15, 20000
    s_cbranch_scc1 SX_4
    s_cmp_eq_u64 vcc, -1
    s_cbranch_scc0 SP_3
SX_4:
UFOK:
    buffer_load_dword v38, v38, s[68:71], 0 offen sc1
    buffer_load_dword v39, v39, s[68:71], 0 offen sc1
    s_barrier
    v_add_u32 v13, s79, v12
    ds_read_b128 v[20:23], v11 offset:0
    ds_read_b128 v[24:27], v13
    s_add_u32 s79, s79, 128
    s_cmp_eq_u32 s79, 1280
    s_cselect_b32 s79, 0, s79
    s_add_u32 m0, s12, 40992
    s_nop 0
    buffer_load_dwordx4 v2, s[52:55], s81 offen offset:0 lds
    buffer_load_dwordx4 v3, s[52:55], s81 offen offset:1024 lds
    buffer_load_dwordx4 v4, s[52:55], s81 offen offset:2048 lds
    buffer_load_dwordx4 v5, s[52:55], s81 offen offset:3072 lds
    s_add_u32 m0, s13, 40992
    s_add_u32 s81, s81, 128
    buffer_load_dwordx4 v6, s[56:59], s82 offen offset:0 lds
    buffer_load_dwordx4 v7, s[56:59], s82 offen offset:1024 lds
    buffer_load_dwordx4 v8, s[56:59], s82 offen offset:2048 lds
    s_add_u32 m0, s13, 53312
    s_nop 0
    buffer_load_dwordx4 v6, s[60:63], s82 offen offset:0 lds
    buffer_load_dwordx4 v7, s[60:63], s82 offen offset:1024 lds
    buffer_load_dwordx4 v8, s[60:63], s82 offen offset:2048 lds
    s_add_u32 s82, s82, 196608
    s_cmp_eq_u32 s82, 1966080
    s_cselect_b32 s82, 0, s82
    s_cselect_b32 s81, s6, s81
    s_waitcnt lgkmcnt(0)
    v_lshlrev_b32 v28, 16, v20
    v_lshlrev_b32 v29, 16, v24
    v_and_b32 v20, 0xffff0000, v20
    v_and_b32 v24, 0xffff0000, v24
    v_fmac_f32 v30, v28, v29
    v_fmac_f32 v30, v20, v24
    v_lshlrev_b32 v28, 16, v21
    v_lshlrev_b32 v29, 16, v25
    v_and_b32 v21, 0xffff0000, v21
    v_and_b32 v25, 0xffff0000, v25
    v_fmac_f32 v30, v28, v29
    v_fmac_f32 v30, v21, v25
    v_lshlrev_b32 v28, 16, v22
    v_lshlrev_b32 v29, 16, v26
    v_and_b32 v22, 0xffff0000, v22
    v_and_b32 v26, 0xffff0000, v26
    v_fmac_f32 v30, v28, v29
    v_fmac_f32 v30, v22, v26
    v_lshlrev_b32 v28, 16, v23
    v_lshlrev_b32 v29, 16, v27
    v_and_b32 v23, 0xffff0000, v23
    v_and_b32 v27, 0xffff0000, v27
    v_fmac_f32 v30, v28, v29
    v_fmac_f32 v30, v23, v27
    s_waitcnt vmcnt(12)
    s_barrier
    v_add_u32 v13, s79, v12
    ds_read_b128 v[20:23], v10 offset:0
    ds_read_b128 v[24:27], v13
    s_add_u32 s79, s79, 128
    s_cmp_eq_u32 s79, 1280
    s_cselect_b32 s79, 0, s79
    s_waitcnt lgkmcnt(0)
    v_lshlrev_b32 v28, 16, v20
    v_lshlrev_b32 v29, 16, v24
    v_and_b32 v20, 0xffff0000, v20
    v_and_b32 v24, 0xffff0000, v24
    v_fmac_f32 v30, v28, v29
    v_fmac_f32 v30, v20, v24
    v_lshlrev_b32 v28, 16, v21
    v_lshlrev_b32 v29, 16, v25
    v_and_b32 v21, 0xffff0000, v21
    v_and_b32 v25, 0xffff0000, v25
    v_fmac_f32 v30, v28, v29
    v_fmac_f32 v30, v21, v25
    v_lshlrev_b32 v28, 16, v22
    v_lshlrev_b32 v29, 16, v26
    v_and_b32 v22, 0xffff0000, v22
    v_and_b32 v26, 0xffff0000, v26
    v_fmac_f32 v30, v28, v29
    v_fmac_f32 v30, v22, v26
    v_lshlrev_b32 v28, 16, v23
    v_lshlrev_b32 v29, 16, v27
    v_and_b32 v23, 0xffff0000, v23
    v_and_b32 v27, 0xffff0000, v27
    v_fmac_f32 v30, v28, v29
    v_fmac_f32 v30, v23, v27
    s_waitcnt vmcnt(0)
    s_barrier
    v_add_u32 v13, s79, v12
    ds_read_b128 v[20:23], v10 offset:40992
    ds_read_b128 v[24:27], v13
    s_add_u32 s79, s79, 128
    s_cmp_eq_u32 s79, 1280
    s_cselect_b32 s79, 0, s79
    s_waitcnt lgkmcnt(0)
    v_lshlrev_b32 v28, 16, v20
    v_lshlrev_b32 v29, 16, v24
    v_and_b32 v20, 0xffff0000, v20
    v_and_b32 v24, 0xffff0000, v24
    v_fmac_f32 v30, v28, v29
    v_fmac_f32 v30, v20, v24
    v_lshlrev_b32 v28, 16, v21
    v_lshlrev_b32 v29, 16, v25
    v_and_b32 v21, 0xffff0000, v21
    v_and_b32 v25, 0xffff0000, v25
    v_fmac_f32 v30, v28, v29
    v_fmac_f32 v30, v21, v25
    v_lshlrev_b32 v28, 16, v22
    v_lshlrev_b32 v29, 16, v26
    v_and_b32 v22, 0xffff0000, v22
    v_and_b32 v26, 0xffff0000, v26
    v_fmac_f32 v30, v28, v29
    v_fmac_f32 v30, v22, v26
    v_lshlrev_b32 v28, 16, v23
    v_lshlrev_b32 v29, 16, v27
    v_and_b32 v23, 0xffff0000, v23
    v_and_b32 v27, 0xffff0000, v27
    v_fmac_f32 v30, v28, v29
    v_fmac_f32 v30, v23, v27
    s_barrier
    s_nop 2
    v_add_f32_dpp v30, v30, v30 quad_perm:[1,0,3,2] row_mask:0xf bank_mask:0xf
    s_nop 2
    v_add_f32_dpp v30, v30, v30 quad_perm:[2,3,0,1] row_mask:0xf bank_mask:0xf
    s_nop 2
    v_add_f32_dpp v30, v30, v30 row_half_mirror row_mask:0xf bank_mask:0xf
    v_mul_f32 v30, 0xbfb8aa3b, v30
    v_exp_f32 v30, v30
    s_lshl_b32 s9, s4, 9
    v_add_f32 v30, 1.0, v30
    v_rcp_f32 v30, v30
    s_lshl_b32 s10, s5, 5
    s_add_u32 s9, s9, s10
    s_add_u32 s9, s9, 12582912
    v_lshlrev_b32 v18, 2, v18
    s_mov_b32 exec_lo, 0x01010101
    s_mov_b32 exec_hi, 0x01010101
    buffer_store_dword v30, v18, s[68:71], s9 offen sc1
    s_lshl_b32 s9, s8, 7
    s_add_u32 s9, s9, 12656896
    s_mov_b32 s15, 0
SP_5:
    s_buffer_load_dwordx16 s[16:31], s[68:71], s9 glc
    s_buffer_load_dwordx16 s[52:67], s[68:71], s9 offset:64 glc
    s_waitcnt lgkmcnt(0)
    s_and_b64 s[16:17], s[16:17], s[66:67]
    s_and_b64 s[16:17], s[16:17], s[64:65]
    s_and_b64 s[16:17], s[16:17], s[62:63]
    s_and_b64 s[16:17], s[16:17], s[60:61]
    s_and_b64 s[16:17], s[16:17], s[58:59]
    s_and_b64 s[16:17], s[16:17], s[56:57]
    s_and_b64 s[16:17], s[16:17], s[54:55]
    s_and_b64 s[16:17], s[16:17], s[52:53]
    s_and_b64 s[16:17], s[16:17], s[30:31]
    s_and_b64 s[16:17], s[16:17], s[28:29]
    s_and_b64 s[16:17], s[16:17], s[26:27]
    s_and_b64 s[16:17], s[16:17], s[24:25]
    s_and_b64 s[16:17], s[16:17], s[22:23]
    s_and_b64 s[16:17], s[16:17], s[20:21]
    s_and_b64 s[16:17], s[16:17], s[18:19]
    s_and_b32 s16, s16, s17
    s_add_u32 s15, s15, 1
    s_cmp_gt_u32 s15, 20000
    s_cbranch_scc1 SX_6
    s_cmp_eq_u32 s16, 1
    s_cbranch_scc1 SX_6
    s_waitcnt vmcnt(0)
    s_branch SP_5
SX_6:
    v_mov_b32 v20, 163328
    v_mov_b32 v21, 1
    ds_write_b32 v20, v21 offset:12
    s_waitcnt vmcnt(0)
    s_mov_b64 exec, 1
    v_mov_b32 v20, 163328
    v_mov_b32 v21, 1
    ds_add_rtn_u32 v20, v20, v21
    s_waitcnt lgkmcnt(0)
    v_readfirstlane_b32 s9, v20
    s_lshl_b32 s10, s4, 7
    s_lshl_b32 s11, s5, 2
    s_cmp_eq_u32 s9, 4
    s_cbranch_scc0 HA_7
    s_add_u32 s10, s10, s11
    s_add_u32 s10, s10, 12649728
    v_mov_b32 v20, s10
    buffer_store_dword v21, v20, s[68:71], 0 offen sc1
HA_7:
    s_mov_b64 exec, -1
    s_lshr_b32 s9, s7, 1
    s_lshl_b32 s9, s9, 7
    s_add_u32 s9, s9, 12649728
    v_mov_b32 v34, 163332
    s_mov_b32 s15, 0
LP_8:
    ds_read_b32 v35, v34
    s_waitcnt lgkmcnt(0)
    v_readfirstlane_b32 s11, v35
    s_add_u32 s15, s15, 1
    s_cmp_gt_u32 s15, 160000
    s_cbranch_scc1 LX_9
    s_cmp_ge_u32 s11, 4
    s_cbranch_scc0 LP_8
LX_9:
    s_mov_b32 s15, 0
SP_10:
    s_buffer_load_dwordx16 s[16:31], s[68:71], s9 glc
    s_waitcnt lgkmcnt(0)
    s_and_b64 s[16:17], s[16:17], s[18:19]
    s_and_b32 s16, s16, s17
    v_mov_b32 v36, s16
    s_and_b64 s[20:21], s[20:21], s[22:23]
    s_and_b32 s17, s20, s21
    v_mov_b32 v37, s17
    s_and_b64 s[24:25], s[24:25], s[26:27]
    s_and_b32 s18, s24, s25
    v_mov_b32 v38, s18
    s_and_b64 s[28:29], s[28:29], s[30:31]
    s_and_b32 s19, s28, s29
    v_mov_b32 v39, s19
    ds_write_b128 v34, v[36:39] offset:12
    s_waitcnt lgkmcnt(0)
    s_and_b64 s[16:17], s[16:17], s[18:19]
    s_and_b32 s16, s16, s17
    s_add_u32 s15, s15, 1
    s_cmp_gt_u32 s15, 20000
    s_cbranch_scc1 SX_11
    s_cmp_eq_u32 s16, 1
    s_cbranch_scc1 SX_11
    ds_read_b32 v35, v34
    s_waitcnt lgkmcnt(0)
    ds_read_b32 v35, v34
    s_waitcnt lgkmcnt(0)
    ds_read_b32 v35, v34
    s_waitcnt lgkmcnt(0)
    ds_read_b32 v35, v34
    s_waitcnt lgkmcnt(0)
    ds_read_b32 v35, v34
    s_waitcnt lgkmcnt(0)
    ds_read_b32 v35, v34
    s_waitcnt lgkmcnt(0)
    s_branch SP_10
SX_11:
    v_mov_b32 v36, 1
    v_mov_b32 v37, 1
    ds_write_b64 v34, v[36:37] offset:12
    ds_write_b64 v34, v[36:37] offset:20
    s_lshl_b32 s9, s7, 8
    s_add_u32 s9, s9, 12582912
    s_mov_b32 m0, 134016
    v_lshlrev_b32 v20, 2, v0
    buffer_load_dword v20, s[68:71], s9 offen sc1 lds
    s_mul_i32 s9, s8, 640
    s_add_u32 s9, s9, 12651776
    v_lshrrev_b32 v20, 3, v0
    v_and_b32 v21, 7, v0
    v_lshlrev_b32 v22, 3, v21
    v_lshl_add_u32 v22, v20, 7, v22
    v_add_u32 v33, s9, v22
    v_mul_u32_u24 v20, 4224, v20
    v_lshl_add_u32 v20, v21, 4, v20
    s_mul_i32 s9, s8, 337920
    s_lshl_b32 s10, s7, 7
    s_add_u32 s9, s9, s10
    v_mov_b32 v34, 163336
    s_mov_b32 s15, 0
LP_12:
    ds_read_b32 v35, v34
    s_waitcnt lgkmcnt(0)
    v_readfirstlane_b32 s11, v35
    s_add_u32 s15, s15, 1
    s_cmp_gt_u32 s15, 160000
    s_cbranch_scc1 LX_13
    s_cmp_ge_u32 s11, 4
    s_cbranch_scc0 LP_12
LX_13:
    s_mul_i32 s10, s8, 640
    s_add_u32 s10, s10, 12651776
    s_mov_b32 s15, 0
SP_14:
    s_buffer_load_dwordx4 s[16:19], s[68:71], s10 offset:0 glc
    s_buffer_load_dwordx4 s[20:23], s[68:71], s10 offset:128 glc
    s_buffer_load_dwordx4 s[24:27], s[68:71], s10 offset:256 glc
    s_buffer_load_dwordx4 s[28:31], s[68:71], s10 offset:384 glc
    s_buffer_load_dwordx4 s[32:35], s[68:71], s10 offset:512 glc
    s_waitcnt lgkmcnt(0)
    s_and_b64 s[16:17], s[16:17], s[34:35]
    s_and_b64 s[16:17], s[16:17], s[32:33]
    s_and_b64 s[16:17], s[16:17], s[30:31]
    s_and_b64 s[16:17], s[16:17], s[28:29]
    s_and_b64 s[16:17], s[16:17], s[26:27]
    s_and_b64 s[16:17], s[16:17], s[24:25]
    s_and_b64 s[16:17], s[16:17], s[22:23]
    s_and_b64 s[16:17], s[16:17], s[20:21]
    s_and_b64 s[16:17], s[16:17], s[18:19]
    s_and_b32 s16, s16, s17
    s_add_u32 s15, s15, 1
    s_cmp_gt_u32 s15, 20000
    s_cbranch_scc1 SX_15
    s_cmp_eq_u32 s16, 16843009
    s_cbranch_scc0 SP_14
SX_15:
    s_mov_b64 exec, -1
    s_mov_b32 m0, 141824
    s_add_u32 s10, s9, 9437184
    buffer_load_dwordx4 v20, s[68:71], s10 offen sc1 lds
    s_mov_b32 m0, 142848
    s_add_u32 s10, s9, 9470976
    buffer_load_dwordx4 v20, s[68:71], s10 offen sc1 lds
    s_mov_b32 m0, 143872
    s_add_u32 s10, s9, 9504768
    buffer_load_dwordx4 v20, s[68:71], s10 offen sc1 lds
    s_mov_b32 m0, 144896
    s_add_u32 s10, s9, 9538560
    buffer_load_dwordx4 v20, s[68:71], s10 offen sc1 lds
    s_mov_b32 m0, 150528
    s_add_u32 s10, s9, 9572352
    buffer_load_dwordx4 v20, s[68:71], s10 offen sc1 lds
    s_mov_b32 m0, 151552
    s_add_u32 s10, s9, 9606144
    buffer_load_dwordx4 v20, s[68:71], s10 offen sc1 lds
    s_mov_b32 m0, 152576
    s_add_u32 s10, s9, 9639936
    buffer_load_dwordx4 v20, s[68:71], s10 offen sc1 lds
    s_mov_b32 m0, 153600
    s_add_u32 s10, s9, 9673728
    buffer_load_dwordx4 v20, s[68:71], s10 offen sc1 lds
    s_mov_b32 m0, 159232
    s_add_u32 s10, s9, 9707520
    buffer_load_dwordx4 v20, s[68:71], s10 offen sc1 lds
    s_mov_b32 m0, 160256
    s_add_u32 s10, s9, 9741312
    buffer_load_dwordx4 v20, s[68:71], s10 offen sc1 lds
    s_waitcnt vmcnt(0)
    s_barrier
    s_endpgm
CPATH:
    s_and_b32 s14, s3, 3
    s_lshl_b32 s12, s14, 12
    s_mul_i32 s13, s14, 3072
    s_mul_i32 s6, s14, 40960
    s_add_u32 s13, s13, 16384
    s_mul_i32 s9, s4, 163840
    v_lshrrev_b32 v10, 3, v0
    v_mul_u32_u24 v10, 1280, v10
    v_add_u32 v10, s9, v10
    v_and_b32 v11, 7, v0
    v_lshrrev_b32 v12, 4, v0
    v_xor_b32 v11, v11, v12
    v_lshl_add_u32 v2, v11, 4, v10
    v_xor_b32 v11, 4, v11
    v_lshl_add_u32 v3, v11, 4, v10
    v_add_u32 v3, 9216, v3
    v_add_u32 v4, 18432, v2
    v_add_u32 v5, 18432, v3
    s_mov_b32 s76, 0x76543210
    s_mov_b32 s77, 0x78541298
    s_lshl_b32 s9, s5, 2
    s_lshr_b64 s[76:77], s[76:77], s9
    s_and_b32 s76, s76, 15
    s_mul_i32 s82, s76, 196608
    s_lshl_b32 s9, s76, 7
    s_add_u32 s81, s9, s6
    s_mul_i32 s9, s14, 49152
    s_mul_i32 s10, s5, 192
    s_add_u32 s9, s9, s10
    v_add_u32 v10, 0, v0
    v_mul_u32_u24 v11, 171, v10
    v_lshrrev_b32 v11, 11, v11
    v_mul_u32_u24 v11, 2880, v11
    v_lshl_add_u32 v11, v0, 4, v11
    v_add_u32 v6, s9, v11
    v_add_u32 v10, 64, v0
    v_mul_u32_u24 v11, 171, v10
    v_lshrrev_b32 v11, 11, v11
    v_mul_u32_u24 v11, 2880, v11
    v_lshl_add_u32 v11, v0, 4, v11
    v_add_u32 v7, s9, v11
    v_add_u32 v10, 128, v0
    v_mul_u32_u24 v11, 171, v10
    v_lshrrev_b32 v11, 11, v11
    v_mul_u32_u24 v11, 2880, v11
    v_lshl_add_u32 v11, v0, 4, v11
    v_add_u32 v8, s9, v11
    s_waitcnt lgkmcnt(0)
    s_mov_b32 s52, s16
    s_mov_b32 s53, s17
    s_mov_b32 s54, 2621440
    s_mov_b32 s55, 0x20000
    s_mov_b32 s56, s36
    s_mov_b32 s57, s37
    s_mov_b32 s58, 1966080
    s_mov_b32 s59, 0x20000
    s_mov_b32 s60, s38
    s_mov_b32 s61, s39
    s_mov_b32 s62, 1966080
    s_mov_b32 s63, 0x20000
    s_mov_b32 s68, s48
    s_mov_b32 s69, s49
    s_mov_b32 s70, 15728640
    s_mov_b32 s71, 0x20000
    s_add_u32 m0, s12, 40992
    s_nop 0
    buffer_load_dwordx4 v2, s[52:55], s81 offen offset:0 lds
    buffer_load_dwordx4 v3, s[52:55], s81 offen offset:1024 lds
    buffer_load_dwordx4 v4, s[52:55], s81 offen offset:2048 lds
    buffer_load_dwordx4 v5, s[52:55], s81 offen offset:3072 lds
    s_add_u32 m0, s13, 40992
    s_add_u32 s81, s81, 128
    buffer_load_dwordx4 v6, s[56:59], s82 offen offset:0 lds
    buffer_load_dwordx4 v7, s[56:59], s82 offen offset:1024 lds
    buffer_load_dwordx4 v8, s[56:59], s82 offen offset:2048 lds
    s_add_u32 m0, s13, 53312
    s_nop 0
    buffer_load_dwordx4 v6, s[60:63], s82 offen offset:0 lds
    buffer_load_dwordx4 v7, s[60:63], s82 offen offset:1024 lds
    buffer_load_dwordx4 v8, s[60:63], s82 offen offset:2048 lds
    s_add_u32 s82, s82, 196608
    s_cmp_eq_u32 s82, 1966080
    s_cselect_b32 s82, 0, s82
    s_cselect_b32 s81, s6, s81
    s_add_u32 m0, s12, 81984
    s_nop 0
    buffer_load_dwordx4 v2, s[52:55], s81 offen offset:0 lds
    buffer_load_dwordx4 v3, s[52:55], s81 offen offset:1024 lds
    buffer_load_dwordx4 v4, s[52:55], s81 offen offset:2048 lds
    buffer_load_dwordx4 v5, s[52:55], s81 offen offset:3072 lds
    s_add_u32 m0, s13, 81984
    s_add_u32 s81, s81, 128
    buffer_load_dwordx4 v6, s[56:59], s82 offen offset:0 lds
    buffer_load_dwordx4 v7, s[56:59], s82 offen offset:1024 lds
    buffer_load_dwordx4 v8, s[56:59], s82 offen offset:2048 lds
    s_add_u32 m0, s13, 94304
    s_nop 0
    buffer_load_dwordx4 v6, s[60:63], s82 offen offset:0 lds
    buffer_load_dwordx4 v7, s[60:63], s82 offen offset:1024 lds
    buffer_load_dwordx4 v8, s[60:63], s82 offen offset:2048 lds
    s_add_u32 s82, s82, 196608
    s_cmp_eq_u32 s82, 1966080
    s_cselect_b32 s82, 0, s82
    s_cselect_b32 s81, s6, s81
    s_mul_i32 s67, s3, 10240
    s_lshl_b32 s64, s8, 2
    s_add_u32 s64, s64, s3
    s_mul_i32 s64, s64, 61440
    s_add_u32 s65, s64, 13631488
    v_lshlrev_b32 v1, 4, v0
    s_mul_i32 s77, s8, 1
    s_lshr_b32 s77, s77, 1
    s_cmp_ge_u32 s77, 12
    s_cselect_b32 s9, 12, 0
    s_sub_u32 s77, s77, s9
    s_add_u32 s66, s65, 61440
    s_mul_i32 s9, s77, 5120
    s_add_u32 s64, s65, s9
    s_add_u32 s79, s64, 30720
    s_cmp_ge_u32 s79, s66
    s_cselect_b32 s9, 61440, 0
    s_sub_u32 s79, s79, s9
    s_lshl_b32 s10, s14, 12
    s_add_u32 s10, s10, 40992
    v_lshrrev_b32 v240, 4, v0
    v_bfe_u32 v241, v0, 2, 2
    v_lshl_add_u32 v241, v240, 3, v241
    v_lshlrev_b32 v241, 7, v241
    v_bfe_u32 v242, v0, 1, 1
    v_bfe_u32 v243, v0, 3, 1
    v_xor_b32 v242, v242, v243
    v_bfe_u32 v243, v0, 4, 1
    v_lshl_add_u32 v242, v243, 2, v242
    v_lshl_add_u32 v241, v242, 4, v241
    v_and_b32 v242, 1, v0
    v_lshl_add_u32 v241, v242, 3, v241
    v_xor_b32 v242, 0, v241
    v_add_u32 v244, s10, v242
    v_xor_b32 v242, 32, v241
    v_add_u32 v245, s10, v242
    v_xor_b32 v242, 64, v241
    v_add_u32 v246, s10, v242
    v_xor_b32 v242, 96, v241
    v_add_u32 v247, s10, v242
    v_and_b32 v242, 15, v0
    v_mul_u32_u24 v242, 4224, v242
    v_lshl_add_u32 v242, v240, 4, v242
    s_bitcmp1_b32 0x877b, s5
    s_cselect_b32 s9, 0, 0x40000000
    v_add_u32 v248, s9, v242
    s_mul_i32 s9, s76, 270336
    s_lshl_b32 s10, s4, 8
    s_add_u32 s9, s9, s10
    s_lshl_b32 s10, s14, 6
    s_add_u32 s9, s9, s10
    s_waitcnt vmcnt(10)
    ds_read_b64_tr_b16 v[224:225], v244 offset:0
    ds_read_b64_tr_b16 v[226:227], v245 offset:512
    ds_read_b64_tr_b16 v[228:229], v245 offset:0
    ds_read_b64_tr_b16 v[230:231], v244 offset:512
    ds_read_b64_tr_b16 v[232:233], v246 offset:0
    ds_read_b64_tr_b16 v[234:235], v247 offset:512
    ds_read_b64_tr_b16 v[236:237], v247 offset:0
    ds_read_b64_tr_b16 v[238:239], v246 offset:512
    s_add_u32 s10, s9, 6291584
    s_waitcnt lgkmcnt(6)
    buffer_store_dwordx4 v[224:227], v248, s[68:71], s10 offen sc1
    s_add_u32 s10, s9, 6359168
    s_waitcnt lgkmcnt(4)
    buffer_store_dwordx4 v[228:231], v248, s[68:71], s10 offen sc1
    s_add_u32 s10, s9, 6426752
    s_waitcnt lgkmcnt(2)
    buffer_store_dwordx4 v[232:235], v248, s[68:71], s10 offen sc1
    s_add_u32 s10, s9, 6494336
    s_waitcnt lgkmcnt(0)
    buffer_store_dwordx4 v[236:239], v248, s[68:71], s10 offen sc1
    s_lshr_b32 s9, s2, 3
    s_and_b32 s9, s9, 7
    s_lshl_b32 s9, s9, 1
    s_bfe_u32 s10, s3, 0x10001
    s_add_u32 s9, s9, s10
    s_mul_i32 s9, s9, 32
    s_lshl_b32 s10, s76, 6
    s_add_u32 s9, s9, s10
    s_add_u32 s9, s9, 128
    s_mul_i32 s10, s5, 192
    v_min_u32 v249, 63, v0
    v_lshrrev_b32 v253, 1, v249
    v_add_u32 v253, s9, v253
    v_subrev_u32 v250, 640, v253
    v_min_u32 v253, v253, v250
    v_mul_u32_u24 v253, 3072, v253
    v_and_b32 v249, 1, v249
    v_lshl_add_u32 v253, v249, 7, v253
    v_add_u32 v251, s10, v253
    s_bitcmp0_b32 s3, 0
    s_cselect_b64 s[50:51], s[36:37], s[38:39]
    global_load_dword v252, v251, s[50:51]
    s_lshr_b32 s12, s3, 1
    s_and_b32 s13, s3, 1
    v_and_b32 v10, 31, v0
    v_lshlrev_b32 v10, 7, v10
    s_lshl_b32 s9, s12, 13
    v_add_u32 v10, s9, v10
    v_bfe_u32 v11, v0, 1, 3
    v_lshrrev_b32 v12, 5, v0
    v_xor_b32 v11, v11, v12
    v_lshl_add_u32 v2, v11, 4, v10
    v_xor_b32 v3, 32, v2
    v_xor_b32 v4, 64, v2
    v_xor_b32 v5, 96, v2
    v_add_u32 v2, 40992, v2
    v_add_u32 v3, 40992, v3
    v_add_u32 v4, 40992, v4
    v_add_u32 v5, 40992, v5
    v_bfe_u32 v10, v0, 4, 1
    v_mul_u32_u24 v13, 12320, v10
    v_bfe_u32 v11, v0, 2, 2
    v_lshl_add_u32 v11, v12, 3, v11
    v_mul_u32_u24 v11, 192, v11
    v_add_u32 v13, v13, v11
    v_and_b32 v11, 3, v0
    v_lshl_add_u32 v13, v11, 3, v13
    s_mul_i32 s9, s13, 96
    s_add_u32 s9, s9, 57376
    v_add_u32 v6, s9, v13
    v_and_b32 v11, 15, v0
    v_lshlrev_b32 v11, 4, v11
    v_lshl_add_u32 v11, v12, 8, v11
    v_lshl_add_u32 v7, v10, 10, v11
    s_mov_b32 s72, s44
    s_mov_b32 s73, s45
    s_mov_b32 s74, 2621440
    s_mov_b32 s75, 0x20000
    v_mov_b32 v12, 0
    v_mov_b32 v13, 0
    v_mov_b32 v14, 0
    v_mov_b32 v15, 0
    v_mov_b32 v16, 0
    v_mov_b32 v17, 0
    v_mov_b32 v18, 0
    v_mov_b32 v19, 0
    v_mov_b32 v20, 0
    v_mov_b32 v21, 0
    v_mov_b32 v22, 0
    v_mov_b32 v23, 0
    v_mov_b32 v24, 0
    v_mov_b32 v25, 0
    v_mov_b32 v26, 0
    v_mov_b32 v27, 0
    v_mov_b32 v28, 0
    v_mov_b32 v29, 0
    v_mov_b32 v30, 0
    v_mov_b32 v31, 0
    v_mov_b32 v32, 0
    v_mov_b32 v33, 0
    v_mov_b32 v34, 0
    v_mov_b32 v35, 0
    v_mov_b32 v36, 0
    v_mov_b32 v37, 0
    v_mov_b32 v38, 0
    v_mov_b32 v39, 0
    v_mov_b32 v40, 0
    v_mov_b32 v41, 0
    v_mov_b32 v42, 0
    v_mov_b32 v43, 0
    v_mov_b32 v44, 0
    v_mov_b32 v45, 0
    v_mov_b32 v46, 0
    v_mov_b32 v47, 0
    v_mov_b32 v48, 0
    v_mov_b32 v49, 0
    v_mov_b32 v50, 0
    v_mov_b32 v51, 0
    v_mov_b32 v52, 0
    v_mov_b32 v53, 0
    v_mov_b32 v54, 0
    v_mov_b32 v55, 0
    v_mov_b32 v56, 0
    v_mov_b32 v57, 0
    v_mov_b32 v58, 0
    v_mov_b32 v59, 0
    v_mov_b32 v60, 0
    v_mov_b32 v61, 0
    v_mov_b32 v62, 0
    v_mov_b32 v63, 0
    v_mov_b32 v64, 0
    v_mov_b32 v65, 0
    v_mov_b32 v66, 0
    v_mov_b32 v67, 0
    v_mov_b32 v68, 0
    v_mov_b32 v69, 0
    v_mov_b32 v70, 0
    v_mov_b32 v71, 0
    v_mov_b32 v72, 0
    v_mov_b32 v73, 0
    v_mov_b32 v74, 0
    v_mov_b32 v75, 0
    v_mov_b32 v76, 0
    v_mov_b32 v77, 0
    v_mov_b32 v78, 0
    v_mov_b32 v79, 0
    v_mov_b32 v80, 0
    v_mov_b32 v81, 0
    v_mov_b32 v82, 0
    v_mov_b32 v83, 0
    v_mov_b32 v84, 0
    v_mov_b32 v85, 0
    v_mov_b32 v86, 0
    v_mov_b32 v87, 0
    v_mov_b32 v88, 0
    v_mov_b32 v89, 0
    v_mov_b32 v90, 0
    v_mov_b32 v91, 0
    v_mov_b32 v92, 0
    v_mov_b32 v93, 0
    v_mov_b32 v94, 0
    v_mov_b32 v95, 0
    v_mov_b32 v96, 0
    v_mov_b32 v97, 0
    v_mov_b32 v98, 0
    v_mov_b32 v99, 0
    v_mov_b32 v100, 0
    v_mov_b32 v101, 0
    v_mov_b32 v102, 0
    v_mov_b32 v103, 0
    v_mov_b32 v104, 0
    v_mov_b32 v105, 0
    v_mov_b32 v106, 0
    v_mov_b32 v107, 0
    s_waitcnt lgkmcnt(0)
    s_mov_b32 s80, 0
    s_mov_b32 s81, 1
    s_mov_b32 s83, -81984
    s_barrier
    ds_read_b128 v[120:123], v2 offset:0
    ds_read_b64_tr_b16 v[108:109], v6 offset:0
    ds_read_b64_tr_b16 v[110:111], v6 offset:768
    ds_read_b128 v[124:127], v2 offset:4096
    ds_read_b64_tr_b16 v[112:113], v6 offset:32
    ds_read_b64_tr_b16 v[114:115], v6 offset:800
    ds_read_b64_tr_b16 v[116:117], v6 offset:64
    ds_read_b64_tr_b16 v[118:119], v6 offset:832
G1:
    s_cmp_eq_u32 s81, 2
    s_cselect_b32 s82, s83, 40992
    s_cselect_b32 s81, -1, s81
    s_add_u32 s81, s81, 1
    s_waitcnt lgkmcnt(5)
    v_mfma_f32_32x32x16_bf16 v[12:27], v[108:111], v[120:123], v[12:27]
    ds_read_b128 v[140:143], v3 offset:0
    ds_read_b64_tr_b16 v[128:129], v6 offset:3072
    s_waitcnt lgkmcnt(6)
    v_mfma_f32_32x32x16_bf16 v[60:75], v[108:111], v[124:127], v[60:75]
    ds_read_b64_tr_b16 v[130:131], v6 offset:3840
    ds_read_b128 v[144:147], v3 offset:4096
    s_waitcnt lgkmcnt(6)
    v_mfma_f32_32x32x16_bf16 v[28:43], v[112:115], v[120:123], v[28:43]
    ds_read_b64_tr_b16 v[132:133], v6 offset:3104
    ds_read_b64_tr_b16 v[134:135], v6 offset:3872
    v_mfma_f32_32x32x16_bf16 v[76:91], v[112:115], v[124:127], v[76:91]
    ds_read_b64_tr_b16 v[136:137], v6 offset:3136
    ds_read_b64_tr_b16 v[138:139], v6 offset:3904
    s_waitcnt lgkmcnt(8)
    v_mfma_f32_32x32x16_bf16 v[44:59], v[116:119], v[120:123], v[44:59]
    v_add_u32 v2, s82, v2
    v_add_u32 v3, s82, v3
    v_mfma_f32_32x32x16_bf16 v[92:107], v[116:119], v[124:127], v[92:107]
    s_waitcnt lgkmcnt(5)
    v_mfma_f32_32x32x16_bf16 v[12:27], v[128:131], v[140:143], v[12:27]
    ds_read_b128 v[120:123], v4 offset:0
    ds_read_b64_tr_b16 v[108:109], v6 offset:6144
    s_waitcnt lgkmcnt(6)
    v_mfma_f32_32x32x16_bf16 v[60:75], v[128:131], v[144:147], v[60:75]
    ds_read_b64_tr_b16 v[110:111], v6 offset:6912
    ds_read_b128 v[124:127], v4 offset:4096
    s_waitcnt lgkmcnt(6)
    v_mfma_f32_32x32x16_bf16 v[28:43], v[132:135], v[140:143], v[28:43]
    ds_read_b64_tr_b16 v[112:113], v6 offset:6176
    ds_read_b64_tr_b16 v[114:115], v6 offset:6944
    v_mfma_f32_32x32x16_bf16 v[76:91], v[132:135], v[144:147], v[76:91]
    ds_read_b64_tr_b16 v[116:117], v6 offset:6208
    ds_read_b64_tr_b16 v[118:119], v6 offset:6976
    s_waitcnt lgkmcnt(8)
    v_mfma_f32_32x32x16_bf16 v[44:59], v[136:139], v[140:143], v[44:59]
    v_add_u32 v4, s82, v4
    v_mfma_f32_32x32x16_bf16 v[92:107], v[136:139], v[144:147], v[92:107]
    s_waitcnt lgkmcnt(5)
    v_mfma_f32_32x32x16_bf16 v[12:27], v[108:111], v[120:123], v[12:27]
    ds_read_b128 v[140:143], v5 offset:0
    ds_read_b64_tr_b16 v[128:129], v6 offset:9216
    s_waitcnt lgkmcnt(6)
    v_mfma_f32_32x32x16_bf16 v[60:75], v[108:111], v[124:127], v[60:75]
    ds_read_b64_tr_b16 v[130:131], v6 offset:9984
    ds_read_b128 v[144:147], v5 offset:4096
    s_waitcnt lgkmcnt(6)
    v_mfma_f32_32x32x16_bf16 v[28:43], v[112:115], v[120:123], v[28:43]
    ds_read_b64_tr_b16 v[132:133], v6 offset:9248
    ds_read_b64_tr_b16 v[134:135], v6 offset:10016
    v_mfma_f32_32x32x16_bf16 v[76:91], v[112:115], v[124:127], v[76:91]
    ds_read_b64_tr_b16 v[136:137], v6 offset:9280
    ds_read_b64_tr_b16 v[138:139], v6 offset:10048
    s_waitcnt lgkmcnt(8)
    v_mfma_f32_32x32x16_bf16 v[44:59], v[116:119], v[120:123], v[44:59]
    v_add_u32 v5, s82, v5
    v_add_u32 v6, s82, v6
    v_mfma_f32_32x32x16_bf16 v[92:107], v[116:119], v[124:127], v[92:107]
    s_waitcnt vmcnt(5)
    s_cmp_eq_u32 s80, 0
    s_cbranch_scc1 G1W
    s_waitcnt vmcnt(1)
G1W:
    s_waitcnt lgkmcnt(0)
    v_mfma_f32_32x32x16_bf16 v[12:27], v[128:131], v[140:143], v[12:27]
    s_barrier
    ds_read_b128 v[120:123], v2 offset:0
    ds_read_b64_tr_b16 v[108:109], v6 offset:0
    v_mfma_f32_32x32x16_bf16 v[60:75], v[128:131], v[144:147], v[60:75]
    ds_read_b64_tr_b16 v[110:111], v6 offset:768
    ds_read_b128 v[124:127], v2 offset:4096
    v_mfma_f32_32x32x16_bf16 v[28:43], v[132:135], v[140:143], v[28:43]
    ds_read_b64_tr_b16 v[112:113], v6 offset:32
    ds_read_b64_tr_b16 v[114:115], v6 offset:800
    v_mfma_f32_32x32x16_bf16 v[76:91], v[132:135], v[144:147], v[76:91]
    ds_read_b64_tr_b16 v[116:117], v6 offset:64
    ds_read_b64_tr_b16 v[118:119], v6 offset:832
    v_mfma_f32_32x32x16_bf16 v[44:59], v[136:139], v[140:143], v[44:59]
    s_add_u32 s80, s80, 1
    s_cmp_lt_u32 s80, 9
    v_mfma_f32_32x32x16_bf16 v[92:107], v[136:139], v[144:147], v[92:107]
    s_cbranch_scc1 G1
    s_lshl_b32 s9, s4, 1
    s_add_u32 s9, s9, s12
    s_mul_i32 s9, s9, 196608
    s_mul_i32 s10, s5, 6
    s_mul_i32 s11, s13, 3
    s_add_u32 s10, s10, s11
    s_add_u32 s11, s10, 0
    s_lshr_b32 s15, s11, 1
    s_lshl_b32 s15, s15, 12
    s_and_b32 s11, s11, 1
    s_lshl_b32 s11, s11, 9
    s_add_u32 s11, s11, s15
    s_add_u32 s80, s11, s9
    s_add_u32 s11, s10, 1
    s_lshr_b32 s15, s11, 1
    s_lshl_b32 s15, s15, 12
    s_and_b32 s11, s11, 1
    s_lshl_b32 s11, s11, 9
    s_add_u32 s11, s11, s15
    s_add_u32 s81, s11, s9
    s_add_u32 s11, s10, 2
    s_lshr_b32 s15, s11, 1
    s_lshl_b32 s15, s15, 12
    s_and_b32 s11, s11, 1
    s_lshl_b32 s11, s11, 9
    s_add_u32 s11, s11, s15
    s_add_u32 s82, s11, s9
    s_waitcnt lgkmcnt(5)
    v_mfma_f32_32x32x16_bf16 v[12:27], v[108:111], v[120:123], v[12:27]
    ds_read_b128 v[140:143], v3 offset:0
    ds_read_b64_tr_b16 v[128:129], v6 offset:3072
    s_waitcnt lgkmcnt(6)
    v_mfma_f32_32x32x16_bf16 v[60:75], v[108:111], v[124:127], v[60:75]
    ds_read_b64_tr_b16 v[130:131], v6 offset:3840
    ds_read_b128 v[144:147], v3 offset:4096
    s_waitcnt lgkmcnt(6)
    v_mfma_f32_32x32x16_bf16 v[28:43], v[112:115], v[120:123], v[28:43]
    ds_read_b64_tr_b16 v[132:133], v6 offset:3104
    ds_read_b64_tr_b16 v[134:135], v6 offset:3872
    v_mfma_f32_32x32x16_bf16 v[76:91], v[112:115], v[124:127], v[76:91]
    ds_read_b64_tr_b16 v[136:137], v6 offset:3136
    ds_read_b64_tr_b16 v[138:139], v6 offset:3904
    s_waitcnt lgkmcnt(8)
    v_mfma_f32_32x32x16_bf16 v[44:59], v[116:119], v[120:123], v[44:59]
    ds_read_b128 v[160:163], v5 offset:0
    ds_read_b64_tr_b16 v[148:149], v6 offset:9216
    v_mfma_f32_32x32x16_bf16 v[92:107], v[116:119], v[124:127], v[92:107]
    ds_read_b64_tr_b16 v[150:151], v6 offset:9984
    ds_read_b128 v[164:167], v5 offset:4096
    s_waitcnt lgkmcnt(9)
    v_mfma_f32_32x32x16_bf16 v[12:27], v[128:131], v[140:143], v[12:27]
    ds_read_b128 v[120:123], v4 offset:0
    ds_read_b64_tr_b16 v[108:109], v6 offset:6144
    s_waitcnt lgkmcnt(10)
    v_mfma_f32_32x32x16_bf16 v[60:75], v[128:131], v[144:147], v[60:75]
    ds_read_b64_tr_b16 v[110:111], v6 offset:6912
    ds_read_b128 v[124:127], v4 offset:4096
    s_waitcnt lgkmcnt(10)
    v_mfma_f32_32x32x16_bf16 v[28:43], v[132:135], v[140:143], v[28:43]
    ds_read_b64_tr_b16 v[112:113], v6 offset:6176
    ds_read_b64_tr_b16 v[114:115], v6 offset:6944
    v_mfma_f32_32x32x16_bf16 v[76:91], v[132:135], v[144:147], v[76:91]
    ds_read_b64_tr_b16 v[116:117], v6 offset:6208
    ds_read_b64_tr_b16 v[118:119], v6 offset:6976
    s_waitcnt lgkmcnt(12)
    v_mfma_f32_32x32x16_bf16 v[44:59], v[136:139], v[140:143], v[44:59]
    ds_read_b64_tr_b16 v[152:153], v6 offset:9248
    ds_read_b64_tr_b16 v[154:155], v6 offset:10016
    v_mfma_f32_32x32x16_bf16 v[92:107], v[136:139], v[144:147], v[92:107]
    ds_read_b64_tr_b16 v[156:157], v6 offset:9280
    ds_read_b64_tr_b16 v[158:159], v6 offset:10048
    s_setprio 3
    s_waitcnt lgkmcnt(9)
    v_mfma_f32_32x32x16_bf16 v[12:27], v[108:111], v[120:123], v[12:27]
    s_waitcnt lgkmcnt(8)
    v_mfma_f32_32x32x16_bf16 v[60:75], v[108:111], v[124:127], v[60:75]
    v_mfma_f32_32x32x16_bf16 v[12:27], v[148:151], v[160:163], v[12:27]
    s_waitcnt lgkmcnt(0)
    v_mfma_f32_32x32x16_bf16 v[60:75], v[148:151], v[164:167], v[60:75]
    s_barrier
    v_mfma_f32_32x32x16_bf16 v[28:43], v[112:115], v[120:123], v[28:43]
    s_nop 7
    s_nop 0
    v_mul_f32 v12, v12, v20
    v_mul_f32 v13, v13, v21
    v_mul_f32 v14, v14, v22
    v_mul_f32 v15, v15, v23
    v_mul_f32 v16, v16, v24
    v_mul_f32 v17, v17, v25
    v_mul_f32 v18, v18, v26
    v_mul_f32 v19, v19, v27
    v_mfma_f32_32x32x16_bf16 v[76:91], v[112:115], v[124:127], v[76:91]
    v_cvt_pk_bf16_f32 v12, v12, v13
    v_cvt_pk_bf16_f32 v13, v14, v15
    v_cvt_pk_bf16_f32 v14, v16, v17
    v_cvt_pk_bf16_f32 v15, v18, v19
    buffer_store_dwordx4 v[12:15], v7, s[68:71], s80 offen offset:0 sc1
    v_mfma_f32_32x32x16_bf16 v[28:43], v[152:155], v[160:163], v[28:43]
    v_mul_f32 v60, v60, v68
    v_mul_f32 v61, v61, v69
    v_mul_f32 v62, v62, v70
    v_mul_f32 v63, v63, v71
    v_mul_f32 v64, v64, v72
    v_mul_f32 v65, v65, v73
    v_mul_f32 v66, v66, v74
    v_mul_f32 v67, v67, v75
    v_mfma_f32_32x32x16_bf16 v[76:91], v[152:155], v[164:167], v[76:91]
    v_cvt_pk_bf16_f32 v60, v60, v61
    v_cvt_pk_bf16_f32 v61, v62, v63
    v_cvt_pk_bf16_f32 v62, v64, v65
    v_cvt_pk_bf16_f32 v63, v66, v67
    buffer_store_dwordx4 v[60:63], v7, s[68:71], s80 offen offset:2048 sc1
    v_mfma_f32_32x32x16_bf16 v[44:59], v[116:119], v[120:123], v[44:59]
    s_nop 7
    s_nop 0
    v_mul_f32 v28, v28, v36
    v_mul_f32 v29, v29, v37
    v_mul_f32 v30, v30, v38
    v_mul_f32 v31, v31, v39
    v_mul_f32 v32, v32, v40
    v_mul_f32 v33, v33, v41
    v_mul_f32 v34, v34, v42
    v_mul_f32 v35, v35, v43
    v_mfma_f32_32x32x16_bf16 v[92:107], v[116:119], v[124:127], v[92:107]
    v_cvt_pk_bf16_f32 v28, v28, v29
    v_cvt_pk_bf16_f32 v29, v30, v31
    v_cvt_pk_bf16_f32 v30, v32, v33
    v_cvt_pk_bf16_f32 v31, v34, v35
    buffer_store_dwordx4 v[28:31], v7, s[68:71], s81 offen offset:0 sc1
    v_mfma_f32_32x32x16_bf16 v[44:59], v[156:159], v[160:163], v[44:59]
    v_mul_f32 v76, v76, v84
    v_mul_f32 v77, v77, v85
    v_mul_f32 v78, v78, v86
    v_mul_f32 v79, v79, v87
    v_mul_f32 v80, v80, v88
    v_mul_f32 v81, v81, v89
    v_mul_f32 v82, v82, v90
    v_mul_f32 v83, v83, v91
    v_mfma_f32_32x32x16_bf16 v[92:107], v[156:159], v[164:167], v[92:107]
    v_cvt_pk_bf16_f32 v76, v76, v77
    v_cvt_pk_bf16_f32 v77, v78, v79
    v_cvt_pk_bf16_f32 v78, v80, v81
    v_cvt_pk_bf16_f32 v79, v82, v83
    buffer_store_dwordx4 v[76:79], v7, s[68:71], s81 offen offset:2048 sc1
    s_nop 4
    v_mul_f32 v44, v44, v52
    v_mul_f32 v45, v45, v53
    v_mul_f32 v46, v46, v54
    v_mul_f32 v47, v47, v55
    v_mul_f32 v48, v48, v56
    v_mul_f32 v49, v49, v57
    v_mul_f32 v50, v50, v58
    v_mul_f32 v51, v51, v59
    v_cvt_pk_bf16_f32 v44, v44, v45
    v_cvt_pk_bf16_f32 v45, v46, v47
    v_cvt_pk_bf16_f32 v46, v48, v49
    v_cvt_pk_bf16_f32 v47, v50, v51
    buffer_store_dwordx4 v[44:47], v7, s[68:71], s82 offen offset:0 sc1
    v_mul_f32 v92, v92, v100
    v_mul_f32 v93, v93, v101
    v_mul_f32 v94, v94, v102
    v_mul_f32 v95, v95, v103
    v_mul_f32 v96, v96, v104
    v_mul_f32 v97, v97, v105
    v_mul_f32 v98, v98, v106
    v_mul_f32 v99, v99, v107
    v_cvt_pk_bf16_f32 v92, v92, v93
    v_cvt_pk_bf16_f32 v93, v94, v95
    v_cvt_pk_bf16_f32 v94, v96, v97
    v_cvt_pk_bf16_f32 v95, v98, v99
    buffer_store_dwordx4 v[92:95], v7, s[68:71], s82 offen offset:2048 sc1
    s_waitcnt lgkmcnt(0)
    v_add_u32 v2, 4096, v1
    v_add_u32 v3, s67, v1
    v_mov_b32 v8, 163340
    s_mov_b32 s15, 0
LP_16:
    ds_read_b32 v9, v8
    s_waitcnt lgkmcnt(0)
    v_readfirstlane_b32 s11, v9
    s_add_u32 s15, s15, 1
    s_cmp_gt_u32 s15, 160000
    s_cbranch_scc1 LX_17
    s_cmp_ge_u32 s11, 1
    s_cbranch_scc0 LP_16
LX_17:
    buffer_load_dwordx4 v[148:151], v1, s[68:71], s64 offen offset:0 sc1
    buffer_load_dwordx4 v[152:155], v1, s[68:71], s64 offen offset:1024 sc1
    buffer_load_dwordx4 v[156:159], v1, s[68:71], s64 offen offset:2048 sc1
    buffer_load_dwordx4 v[160:163], v1, s[68:71], s64 offen offset:3072 sc1
    buffer_load_dwordx4 v[164:167], v2, s[68:71], s64 offen offset:0 sc1
    s_add_u32 s64, s64, 5120
    s_cmp_eq_u32 s64, s66
    s_cselect_b32 s64, s65, s64
    s_mul_i32 s14, s7, 196608
    s_mul_i32 s9, s3, 49152
    s_add_u32 s14, s14, s9
    s_add_u32 s81, s14, 49152
    s_lshl_b32 s9, s77, 12
    s_add_u32 s80, s14, s9
    s_add_u32 s9, s3, 0
    s_and_b32 s9, s9, 3
    s_lshl_b32 s9, s9, 10
    v_add_u32 v4, s9, v1
    s_add_u32 s9, s3, 1
    s_and_b32 s9, s9, 3
    s_lshl_b32 s9, s9, 10
    v_add_u32 v5, s9, v1
    s_add_u32 s9, s3, 2
    s_and_b32 s9, s9, 3
    s_lshl_b32 s9, s9, 10
    v_add_u32 v6, s9, v1
    s_add_u32 s9, s3, 3
    s_and_b32 s9, s9, 3
    s_lshl_b32 s9, s9, 10
    v_add_u32 v7, s9, v1
    s_waitcnt vmcnt(5)
    s_mov_b64 exec, 1
    v_mov_b32 v8, 163328
    v_mov_b32 v9, 1
    ds_add_rtn_u32 v8, v8, v9
    s_waitcnt lgkmcnt(0)
    v_readfirstlane_b32 s9, v8
    s_lshl_b32 s10, s4, 7
    s_lshl_b32 s11, s5, 2
    s_cmp_eq_u32 s9, 4
    s_cbranch_scc0 HA_18
    s_add_u32 s10, s10, s11
    s_add_u32 s10, s10, 12649728
    v_mov_b32 v8, s10
    buffer_store_dword v9, v8, s[68:71], 0 offen sc1
HA_18:
    s_mov_b64 exec, -1
    s_setprio 3
    buffer_load_dwordx4 v[168:171], v1, s[68:71], s64 offen offset:0 sc1
    buffer_load_dwordx4 v[172:175], v1, s[68:71], s64 offen offset:1024 sc1
    buffer_load_dwordx4 v[176:179], v1, s[68:71], s64 offen offset:2048 sc1
    buffer_load_dwordx4 v[180:183], v1, s[68:71], s64 offen offset:3072 sc1
    buffer_load_dwordx4 v[184:187], v2, s[68:71], s64 offen offset:0 sc1
    s_add_u32 s64, s64, 5120
    s_cmp_eq_u32 s64, s66
    s_cselect_b32 s64, s65, s64
    buffer_load_dwordx4 v[188:191], v1, s[68:71], s64 offen offset:0 sc1
    buffer_load_dwordx4 v[192:195], v1, s[68:71], s64 offen offset:1024 sc1
    buffer_load_dwordx4 v[196:199], v1, s[68:71], s64 offen offset:2048 sc1
    buffer_load_dwordx4 v[200:203], v1, s[68:71], s64 offen offset:3072 sc1
    buffer_load_dwordx4 v[204:207], v2, s[68:71], s64 offen offset:0 sc1
    s_add_u32 s64, s64, 5120
    s_cmp_eq_u32 s64, s66
    s_cselect_b32 s64, s65, s64
    buffer_load_dwordx4 v[88:91], v1, s[68:71], s64 offen offset:0 sc1
    buffer_load_dwordx4 v[92:95], v1, s[68:71], s64 offen offset:1024 sc1
    buffer_load_dwordx4 v[96:99], v1, s[68:71], s64 offen offset:2048 sc1
    buffer_load_dwordx4 v[100:103], v1, s[68:71], s64 offen offset:3072 sc1
    buffer_load_dwordx4 v[104:107], v2, s[68:71], s64 offen offset:0 sc1
    s_add_u32 s64, s64, 5120
    s_cmp_eq_u32 s64, s66
    s_cselect_b32 s64, s65, s64
    v_mov_b32 v0, 163332
    s_mov_b64 exec, 1
    ds_inc_u32 v0, v0
    s_mov_b64 exec, -1
    s_nop 2
    buffer_load_dwordx4 v[108:111], v1, s[68:71], s64 offen offset:0 sc1
    buffer_load_dwordx4 v[112:115], v1, s[68:71], s64 offen offset:1024 sc1
    buffer_load_dwordx4 v[116:119], v1, s[68:71], s64 offen offset:2048 sc1
    buffer_load_dwordx4 v[120:123], v1, s[68:71], s64 offen offset:3072 sc1
    buffer_load_dwordx4 v[124:127], v2, s[68:71], s64 offen offset:0 sc1
    s_add_u32 s64, s64, 5120
    s_cmp_eq_u32 s64, s66
    s_cselect_b32 s64, s65, s64
    buffer_load_dwordx4 v[128:131], v1, s[68:71], s64 offen offset:0 sc1
    buffer_load_dwordx4 v[132:135], v1, s[68:71], s64 offen offset:1024 sc1
    buffer_load_dwordx4 v[136:139], v1, s[68:71], s64 offen offset:2048 sc1
    buffer_load_dwordx4 v[140:143], v1, s[68:71], s64 offen offset:3072 sc1
    buffer_load_dwordx4 v[144:147], v2, s[68:71], s64 offen offset:0 sc1
    s_add_u32 s64, s64, 5120
    s_cmp_eq_u32 s64, s66
    s_cselect_b32 s64, s65, s64
    s_add_u32 m0, s67, 0
    s_nop 0
    buffer_load_dwordx4 v1, s[68:71], s79 offen offset:0 sc1 lds
    buffer_load_dwordx4 v1, s[68:71], s79 offen offset:1024 sc1 lds
    buffer_load_dwordx4 v1, s[68:71], s79 offen offset:2048 sc1 lds
    buffer_load_dwordx4 v1, s[68:71], s79 offen offset:3072 sc1 lds
    s_add_u32 m0, s67, 4096
    s_nop 0
    buffer_load_dwordx4 v2, s[68:71], s79 offen offset:0 sc1 lds
    s_add_u32 s79, s79, 5120
    s_cmp_eq_u32 s79, s66
    s_cselect_b32 s79, s65, s79
    s_add_u32 m0, s67, 5120
    s_nop 0
    buffer_load_dwordx4 v1, s[68:71], s79 offen offset:0 sc1 lds
    buffer_load_dwordx4 v1, s[68:71], s79 offen offset:1024 sc1 lds
    buffer_load_dwordx4 v1, s[68:71], s79 offen offset:2048 sc1 lds
    buffer_load_dwordx4 v1, s[68:71], s79 offen offset:3072 sc1 lds
    s_add_u32 m0, s67, 9216
    s_nop 0
    buffer_load_dwordx4 v2, s[68:71], s79 offen offset:0 sc1 lds
    s_add_u32 s79, s79, 5120
    s_cmp_eq_u32 s79, s66
    s_cselect_b32 s79, s65, s79
    s_add_u32 m0, s67, 40992
    s_nop 0
    buffer_load_dwordx4 v1, s[68:71], s79 offen offset:0 sc1 lds
    buffer_load_dwordx4 v1, s[68:71], s79 offen offset:1024 sc1 lds
    buffer_load_dwordx4 v1, s[68:71], s79 offen offset:2048 sc1 lds
    buffer_load_dwordx4 v1, s[68:71], s79 offen offset:3072 sc1 lds
    s_add_u32 m0, s67, 45088
    s_nop 0
    buffer_load_dwordx4 v2, s[68:71], s79 offen offset:0 sc1 lds
    s_add_u32 s79, s79, 5120
    s_cmp_eq_u32 s79, s66
    s_cselect_b32 s79, s65, s79
    s_add_u32 m0, s67, 46112
    s_nop 0
    buffer_load_dwordx4 v1, s[68:71], s79 offen offset:0 sc1 lds
    buffer_load_dwordx4 v1, s[68:71], s79 offen offset:1024 sc1 lds
    buffer_load_dwordx4 v1, s[68:71], s79 offen offset:2048 sc1 lds
    buffer_load_dwordx4 v1, s[68:71], s79 offen offset:3072 sc1 lds
    s_add_u32 m0, s67, 50208
    s_nop 0
    buffer_load_dwordx4 v2, s[68:71], s79 offen offset:0 sc1 lds
    s_add_u32 s79, s79, 5120
    s_cmp_eq_u32 s79, s66
    s_cselect_b32 s79, s65, s79
    s_lshl_b32 s9, s3, 2
    s_add_u32 s9, s9, 163344
    v_mov_b32 v8, s9
    s_mov_b32 s15, 0
LP_19:
    ds_read_b32 v9, v8
    s_waitcnt lgkmcnt(0)
    v_readfirstlane_b32 s11, v9
    s_add_u32 s15, s15, 1
    s_cmp_gt_u32 s15, 160000
    s_cbranch_scc1 LX_20
    s_cmp_ge_u32 s11, 1
    s_cbranch_scc0 LP_19
LX_20:
    s_setprio 1
    buffer_load_dwordx4 v[212:215], v5, s[68:71], s80 offen sc1
    buffer_load_dwordx4 v[216:219], v6, s[68:71], s80 offen sc1
    buffer_load_dwordx4 v[220:223], v7, s[68:71], s80 offen sc1
    buffer_load_dwordx4 v[208:211], v4, s[68:71], s80 offen sc1
    s_add_u32 s80, s80, 4096
    s_cmp_eq_u32 s80, s81
    s_cselect_b32 s80, s14, s80
    buffer_load_dwordx4 v[228:231], v5, s[68:71], s80 offen sc1
    buffer_load_dwordx4 v[232:235], v6, s[68:71], s80 offen sc1
    buffer_load_dwordx4 v[236:239], v7, s[68:71], s80 offen sc1
    buffer_load_dwordx4 v[224:227], v4, s[68:71], s80 offen sc1
    s_add_u32 s80, s80, 4096
    s_cmp_eq_u32 s80, s81
    s_cselect_b32 s80, s14, s80
    buffer_load_dwordx4 v[244:247], v5, s[68:71], s80 offen sc1
    buffer_load_dwordx4 v[248:251], v6, s[68:71], s80 offen sc1
    buffer_load_dwordx4 v[252:255], v7, s[68:71], s80 offen sc1
    buffer_load_dwordx4 v[240:243], v4, s[68:71], s80 offen sc1
    s_add_u32 s80, s80, 4096
    s_cmp_eq_u32 s80, s81
    s_cselect_b32 s80, s14, s80
    s_waitcnt vmcnt(57)
    s_waitcnt vmcnt(11)
    v_mfma_f32_16x16x32_bf16 v[28:31], v[148:151], v[212:215], 0
    v_mfma_f32_16x16x32_bf16 v[32:35], v[152:155], v[212:215], 0
    v_mfma_f32_16x16x32_bf16 v[36:39], v[156:159], v[212:215], 0
    v_mfma_f32_16x16x32_bf16 v[40:43], v[160:163], v[212:215], 0
    v_mfma_f32_16x16x32_bf16 v[44:47], v[164:167], v[212:215], 0
    buffer_load_dwordx4 v[212:215], v5, s[68:71], s80 offen sc1
    s_waitcnt vmcnt(11)
    v_mfma_f32_16x16x32_bf16 v[48:51], v[148:151], v[216:219], 0
    v_mfma_f32_16x16x32_bf16 v[52:55], v[152:155], v[216:219], 0
    v_mfma_f32_16x16x32_bf16 v[56:59], v[156:159], v[216:219], 0
    v_mfma_f32_16x16x32_bf16 v[60:63], v[160:163], v[216:219], 0
    v_mfma_f32_16x16x32_bf16 v[64:67], v[164:167], v[216:219], 0
    buffer_load_dwordx4 v[216:219], v6, s[68:71], s80 offen sc1
    s_waitcnt vmcnt(11)
    v_mfma_f32_16x16x32_bf16 v[68:71], v[148:151], v[220:223], 0
    v_mfma_f32_16x16x32_bf16 v[72:75], v[152:155], v[220:223], 0
    v_mfma_f32_16x16x32_bf16 v[76:79], v[156:159], v[220:223], 0
    v_mfma_f32_16x16x32_bf16 v[80:83], v[160:163], v[220:223], 0
    v_mfma_f32_16x16x32_bf16 v[84:87], v[164:167], v[220:223], 0
    buffer_load_dwordx4 v[220:223], v7, s[68:71], s80 offen sc1
    s_waitcnt vmcnt(11)
    v_mfma_f32_16x16x32_bf16 v[8:11], v[148:151], v[208:211], 0
    v_mfma_f32_16x16x32_bf16 v[12:15], v[152:155], v[208:211], 0
    v_mfma_f32_16x16x32_bf16 v[16:19], v[156:159], v[208:211], 0
    v_mfma_f32_16x16x32_bf16 v[20:23], v[160:163], v[208:211], 0
    v_mfma_f32_16x16x32_bf16 v[24:27], v[164:167], v[208:211], 0
    buffer_load_dwordx4 v[208:211], v4, s[68:71], s80 offen sc1
    s_add_u32 s80, s80, 4096
    s_cmp_eq_u32 s80, s81
    s_cselect_b32 s80, s14, s80
    s_waitcnt vmcnt(11)
    v_mfma_f32_16x16x32_bf16 v[28:31], v[168:171], v[228:231], v[28:31]
    ds_read_b128 v[148:151], v3 offset:0
    v_mfma_f32_16x16x32_bf16 v[32:35], v[172:175], v[228:231], v[32:35]
    v_mfma_f32_16x16x32_bf16 v[36:39], v[176:179], v[228:231], v[36:39]
    ds_read_b128 v[152:155], v3 offset:1024
    v_mfma_f32_16x16x32_bf16 v[40:43], v[180:183], v[228:231], v[40:43]
    v_mfma_f32_16x16x32_bf16 v[44:47], v[184:187], v[228:231], v[44:47]
    buffer_load_dwordx4 v[228:231], v5, s[68:71], s80 offen sc1
    ds_read_b128 v[156:159], v3 offset:2048
    s_waitcnt vmcnt(11)
    v_mfma_f32_16x16x32_bf16 v[48:51], v[168:171], v[232:235], v[48:51]
    v_mfma_f32_16x16x32_bf16 v[52:55], v[172:175], v[232:235], v[52:55]
    ds_read_b128 v[160:163], v3 offset:3072
    v_mfma_f32_16x16x32_bf16 v[56:59], v[176:179], v[232:235], v[56:59]
    v_mfma_f32_16x16x32_bf16 v[60:63], v[180:183], v[232:235], v[60:63]
    ds_read_b128 v[164:167], v3 offset:4096
    v_mfma_f32_16x16x32_bf16 v[64:67], v[184:187], v[232:235], v[64:67]
    buffer_load_dwordx4 v[232:235], v6, s[68:71], s80 offen sc1
    s_waitcnt vmcnt(11)
    v_mfma_f32_16x16x32_bf16 v[68:71], v[168:171], v[236:239], v[68:71]
    v_mfma_f32_16x16x32_bf16 v[72:75], v[172:175], v[236:239], v[72:75]
    v_mfma_f32_16x16x32_bf16 v[76:79], v[176:179], v[236:239], v[76:79]
    v_mfma_f32_16x16x32_bf16 v[80:83], v[180:183], v[236:239], v[80:83]
    v_mfma_f32_16x16x32_bf16 v[84:87], v[184:187], v[236:239], v[84:87]
    buffer_load_dwordx4 v[236:239], v7, s[68:71], s80 offen sc1
    s_waitcnt vmcnt(11)
    v_mfma_f32_16x16x32_bf16 v[8:11], v[168:171], v[224:227], v[8:11]
    v_mfma_f32_16x16x32_bf16 v[12:15], v[172:175], v[224:227], v[12:15]
    v_mfma_f32_16x16x32_bf16 v[16:19], v[176:179], v[224:227], v[16:19]
    v_mfma_f32_16x16x32_bf16 v[20:23], v[180:183], v[224:227], v[20:23]
    v_mfma_f32_16x16x32_bf16 v[24:27], v[184:187], v[224:227], v[24:27]
    buffer_load_dwordx4 v[224:227], v4, s[68:71], s80 offen sc1
    s_add_u32 s80, s80, 4096
    s_cmp_eq_u32 s80, s81
    s_cselect_b32 s80, s14, s80
    s_waitcnt vmcnt(11)
    v_mfma_f32_16x16x32_bf16 v[28:31], v[188:191], v[244:247], v[28:31]
    ds_read_b128 v[168:171], v3 offset:5120
    v_mfma_f32_16x16x32_bf16 v[32:35], v[192:195], v[244:247], v[32:35]
    v_mfma_f32_16x16x32_bf16 v[36:39], v[196:199], v[244:247], v[36:39]
    ds_read_b128 v[172:175], v3 offset:6144
    v_mfma_f32_16x16x32_bf16 v[40:43], v[200:203], v[244:247], v[40:43]
    v_mfma_f32_16x16x32_bf16 v[44:47], v[204:207], v[244:247], v[44:47]
    buffer_load_dwordx4 v[244:247], v5, s[68:71], s80 offen sc1
    ds_read_b128 v[176:179], v3 offset:7168
    s_waitcnt vmcnt(11)
    v_mfma_f32_16x16x32_bf16 v[48:51], v[188:191], v[248:251], v[48:51]
    v_mfma_f32_16x16x32_bf16 v[52:55], v[192:195], v[248:251], v[52:55]
    ds_read_b128 v[180:183], v3 offset:8192
    v_mfma_f32_16x16x32_bf16 v[56:59], v[196:199], v[248:251], v[56:59]
    v_mfma_f32_16x16x32_bf16 v[60:63], v[200:203], v[248:251], v[60:63]
    ds_read_b128 v[184:187], v3 offset:9216
    v_mfma_f32_16x16x32_bf16 v[64:67], v[204:207], v[248:251], v[64:67]
    buffer_load_dwordx4 v[248:251], v6, s[68:71], s80 offen sc1
    s_waitcnt vmcnt(11)
    v_mfma_f32_16x16x32_bf16 v[68:71], v[188:191], v[252:255], v[68:71]
    v_mfma_f32_16x16x32_bf16 v[72:75], v[192:195], v[252:255], v[72:75]
    v_mfma_f32_16x16x32_bf16 v[76:79], v[196:199], v[252:255], v[76:79]
    v_mfma_f32_16x16x32_bf16 v[80:83], v[200:203], v[252:255], v[80:83]
    v_mfma_f32_16x16x32_bf16 v[84:87], v[204:207], v[252:255], v[84:87]
    buffer_load_dwordx4 v[252:255], v7, s[68:71], s80 offen sc1
    s_waitcnt vmcnt(11)
    v_mfma_f32_16x16x32_bf16 v[8:11], v[188:191], v[240:243], v[8:11]
    v_mfma_f32_16x16x32_bf16 v[12:15], v[192:195], v[240:243], v[12:15]
    v_mfma_f32_16x16x32_bf16 v[16:19], v[196:199], v[240:243], v[16:19]
    v_mfma_f32_16x16x32_bf16 v[20:23], v[200:203], v[240:243], v[20:23]
    v_mfma_f32_16x16x32_bf16 v[24:27], v[204:207], v[240:243], v[24:27]
    buffer_load_dwordx4 v[240:243], v4, s[68:71], s80 offen sc1
    s_add_u32 s80, s80, 4096
    s_cmp_eq_u32 s80, s81
    s_cselect_b32 s80, s14, s80
    s_waitcnt vmcnt(11)
    v_mfma_f32_16x16x32_bf16 v[28:31], v[88:91], v[212:215], v[28:31]
    ds_read_b128 v[188:191], v3 offset:40992
    v_mfma_f32_16x16x32_bf16 v[32:35], v[92:95], v[212:215], v[32:35]
    v_mfma_f32_16x16x32_bf16 v[36:39], v[96:99], v[212:215], v[36:39]
    ds_read_b128 v[192:195], v3 offset:42016
    v_mfma_f32_16x16x32_bf16 v[40:43], v[100:103], v[212:215], v[40:43]
    v_mfma_f32_16x16x32_bf16 v[44:47], v[104:107], v[212:215], v[44:47]
    buffer_load_dwordx4 v[212:215], v5, s[68:71], s80 offen sc1
    ds_read_b128 v[196:199], v3 offset:43040
    s_waitcnt vmcnt(11)
    v_mfma_f32_16x16x32_bf16 v[48:51], v[88:91], v[216:219], v[48:51]
    v_mfma_f32_16x16x32_bf16 v[52:55], v[92:95], v[216:219], v[52:55]
    ds_read_b128 v[200:203], v3 offset:44064
    v_mfma_f32_16x16x32_bf16 v[56:59], v[96:99], v[216:219], v[56:59]
    v_mfma_f32_16x16x32_bf16 v[60:63], v[100:103], v[216:219], v[60:63]
    ds_read_b128 v[204:207], v3 offset:45088
    v_mfma_f32_16x16x32_bf16 v[64:67], v[104:107], v[216:219], v[64:67]
    buffer_load_dwordx4 v[216:219], v6, s[68:71], s80 offen sc1
    s_waitcnt vmcnt(11)
    v_mfma_f32_16x16x32_bf16 v[68:71], v[88:91], v[220:223], v[68:71]
    v_mfma_f32_16x16x32_bf16 v[72:75], v[92:95], v[220:223], v[72:75]
    v_mfma_f32_16x16x32_bf16 v[76:79], v[96:99], v[220:223], v[76:79]
    v_mfma_f32_16x16x32_bf16 v[80:83], v[100:103], v[220:223], v[80:83]
    v_mfma_f32_16x16x32_bf16 v[84:87], v[104:107], v[220:223], v[84:87]
    buffer_load_dwordx4 v[220:223], v7, s[68:71], s80 offen sc1
    s_waitcnt vmcnt(11)
    v_mfma_f32_16x16x32_bf16 v[8:11], v[88:91], v[208:211], v[8:11]
    v_mfma_f32_16x16x32_bf16 v[12:15], v[92:95], v[208:211], v[12:15]
    v_mfma_f32_16x16x32_bf16 v[16:19], v[96:99], v[208:211], v[16:19]
    v_mfma_f32_16x16x32_bf16 v[20:23], v[100:103], v[208:211], v[20:23]
    v_mfma_f32_16x16x32_bf16 v[24:27], v[104:107], v[208:211], v[24:27]
    buffer_load_dwordx4 v[208:211], v4, s[68:71], s80 offen sc1
    s_add_u32 s80, s80, 4096
    s_cmp_eq_u32 s80, s81
    s_cselect_b32 s80, s14, s80
    s_waitcnt vmcnt(11)
    v_mfma_f32_16x16x32_bf16 v[28:31], v[108:111], v[228:231], v[28:31]
    ds_read_b128 v[88:91], v3 offset:46112
    v_mfma_f32_16x16x32_bf16 v[32:35], v[112:115], v[228:231], v[32:35]
    v_mfma_f32_16x16x32_bf16 v[36:39], v[116:119], v[228:231], v[36:39]
    ds_read_b128 v[92:95], v3 offset:47136
    v_mfma_f32_16x16x32_bf16 v[40:43], v[120:123], v[228:231], v[40:43]
    v_mfma_f32_16x16x32_bf16 v[44:47], v[124:127], v[228:231], v[44:47]
    buffer_load_dwordx4 v[228:231], v5, s[68:71], s80 offen sc1
    ds_read_b128 v[96:99], v3 offset:48160
    s_waitcnt vmcnt(11)
    v_mfma_f32_16x16x32_bf16 v[48:51], v[108:111], v[232:235], v[48:51]
    v_mfma_f32_16x16x32_bf16 v[52:55], v[112:115], v[232:235], v[52:55]
    ds_read_b128 v[100:103], v3 offset:49184
    v_mfma_f32_16x16x32_bf16 v[56:59], v[116:119], v[232:235], v[56:59]
    v_mfma_f32_16x16x32_bf16 v[60:63], v[120:123], v[232:235], v[60:63]
    ds_read_b128 v[104:107], v3 offset:50208
    v_mfma_f32_16x16x32_bf16 v[64:67], v[124:127], v[232:235], v[64:67]
    buffer_load_dwordx4 v[232:235], v6, s[68:71], s80 offen sc1
    s_waitcnt vmcnt(11)
    v_mfma_f32_16x16x32_bf16 v[68:71], v[108:111], v[236:239], v[68:71]
    v_mfma_f32_16x16x32_bf16 v[72:75], v[112:115], v[236:239], v[72:75]
    v_mfma_f32_16x16x32_bf16 v[76:79], v[116:119], v[236:239], v[76:79]
    v_mfma_f32_16x16x32_bf16 v[80:83], v[120:123], v[236:239], v[80:83]
    v_mfma_f32_16x16x32_bf16 v[84:87], v[124:127], v[236:239], v[84:87]
    buffer_load_dwordx4 v[236:239], v7, s[68:71], s80 offen sc1
    s_waitcnt vmcnt(11)
    v_mfma_f32_16x16x32_bf16 v[8:11], v[108:111], v[224:227], v[8:11]
    v_mfma_f32_16x16x32_bf16 v[12:15], v[112:115], v[224:227], v[12:15]
    v_mfma_f32_16x16x32_bf16 v[16:19], v[116:119], v[224:227], v[16:19]
    v_mfma_f32_16x16x32_bf16 v[20:23], v[120:123], v[224:227], v[20:23]
    v_mfma_f32_16x16x32_bf16 v[24:27], v[124:127], v[224:227], v[24:27]
    buffer_load_dwordx4 v[224:227], v4, s[68:71], s80 offen sc1
    s_add_u32 s80, s80, 4096
    s_cmp_eq_u32 s80, s81
    s_cselect_b32 s80, s14, s80
    s_waitcnt vmcnt(11)
    v_mfma_f32_16x16x32_bf16 v[28:31], v[128:131], v[244:247], v[28:31]
    buffer_load_dwordx4 v[108:111], v1, s[68:71], s79 offen offset:0 sc1
    v_mfma_f32_16x16x32_bf16 v[32:35], v[132:135], v[244:247], v[32:35]
    v_mfma_f32_16x16x32_bf16 v[36:39], v[136:139], v[244:247], v[36:39]
    buffer_load_dwordx4 v[112:115], v1, s[68:71], s79 offen offset:1024 sc1
    v_mfma_f32_16x16x32_bf16 v[40:43], v[140:143], v[244:247], v[40:43]
    v_mfma_f32_16x16x32_bf16 v[44:47], v[144:147], v[244:247], v[44:47]
    buffer_load_dwordx4 v[244:247], v5, s[68:71], s80 offen sc1
    buffer_load_dwordx4 v[116:119], v1, s[68:71], s79 offen offset:2048 sc1
    s_waitcnt vmcnt(14)
    v_mfma_f32_16x16x32_bf16 v[48:51], v[128:131], v[248:251], v[48:51]
    v_mfma_f32_16x16x32_bf16 v[52:55], v[132:135], v[248:251], v[52:55]
    buffer_load_dwordx4 v[120:123], v1, s[68:71], s79 offen offset:3072 sc1
    v_mfma_f32_16x16x32_bf16 v[56:59], v[136:139], v[248:251], v[56:59]
    v_mfma_f32_16x16x32_bf16 v[60:63], v[140:143], v[248:251], v[60:63]
    buffer_load_dwordx4 v[124:127], v2, s[68:71], s79 offen offset:0 sc1
    s_add_u32 s79, s79, 5120
    s_cmp_eq_u32 s79, s66
    s_cselect_b32 s79, s65, s79
    v_mfma_f32_16x16x32_bf16 v[64:67], v[144:147], v[248:251], v[64:67]
    buffer_load_dwordx4 v[248:251], v6, s[68:71], s80 offen sc1
    s_waitcnt vmcnt(16)
    v_mfma_f32_16x16x32_bf16 v[68:71], v[128:131], v[252:255], v[68:71]
    v_mfma_f32_16x16x32_bf16 v[72:75], v[132:135], v[252:255], v[72:75]
    v_mfma_f32_16x16x32_bf16 v[76:79], v[136:139], v[252:255], v[76:79]
    v_mfma_f32_16x16x32_bf16 v[80:83], v[140:143], v[252:255], v[80:83]
    v_mfma_f32_16x16x32_bf16 v[84:87], v[144:147], v[252:255], v[84:87]
    buffer_load_dwordx4 v[252:255], v7, s[68:71], s80 offen sc1
    s_waitcnt vmcnt(16)
    v_mfma_f32_16x16x32_bf16 v[8:11], v[128:131], v[240:243], v[8:11]
    v_mfma_f32_16x16x32_bf16 v[12:15], v[132:135], v[240:243], v[12:15]
    v_mfma_f32_16x16x32_bf16 v[16:19], v[136:139], v[240:243], v[16:19]
    v_mfma_f32_16x16x32_bf16 v[20:23], v[140:143], v[240:243], v[20:23]
    v_mfma_f32_16x16x32_bf16 v[24:27], v[144:147], v[240:243], v[24:27]
    buffer_load_dwordx4 v[240:243], v4, s[68:71], s80 offen sc1
    s_add_u32 s80, s80, 4096
    s_cmp_eq_u32 s80, s81
    s_cselect_b32 s80, s14, s80
    s_waitcnt lgkmcnt(15)
    s_waitcnt vmcnt(16)
    v_mfma_f32_16x16x32_bf16 v[28:31], v[148:151], v[212:215], v[28:31]
    buffer_load_dwordx4 v[128:131], v1, s[68:71], s79 offen offset:0 sc1
    v_mfma_f32_16x16x32_bf16 v[32:35], v[152:155], v[212:215], v[32:35]
    v_mfma_f32_16x16x32_bf16 v[36:39], v[156:159], v[212:215], v[36:39]
    buffer_load_dwordx4 v[132:135], v1, s[68:71], s79 offen offset:1024 sc1
    v_mfma_f32_16x16x32_bf16 v[40:43], v[160:163], v[212:215], v[40:43]
    v_mfma_f32_16x16x32_bf16 v[44:47], v[164:167], v[212:215], v[44:47]
    buffer_load_dwordx4 v[212:215], v5, s[68:71], s80 offen sc1
    buffer_load_dwordx4 v[136:139], v1, s[68:71], s79 offen offset:2048 sc1
    s_waitcnt vmcnt(19)
    v_mfma_f32_16x16x32_bf16 v[48:51], v[148:151], v[216:219], v[48:51]
    v_mfma_f32_16x16x32_bf16 v[52:55], v[152:155], v[216:219], v[52:55]
    buffer_load_dwordx4 v[140:143], v1, s[68:71], s79 offen offset:3072 sc1
    v_mfma_f32_16x16x32_bf16 v[56:59], v[156:159], v[216:219], v[56:59]
    v_mfma_f32_16x16x32_bf16 v[60:63], v[160:163], v[216:219], v[60:63]
    buffer_load_dwordx4 v[144:147], v2, s[68:71], s79 offen offset:0 sc1
    s_add_u32 s79, s79, 5120
    s_cmp_eq_u32 s79, s66
    s_cselect_b32 s79, s65, s79
    v_mfma_f32_16x16x32_bf16 v[64:67], v[164:167], v[216:219], v[64:67]
    buffer_load_dwordx4 v[216:219], v6, s[68:71], s80 offen sc1
    s_waitcnt vmcnt(21)
    v_mfma_f32_16x16x32_bf16 v[68:71], v[148:151], v[220:223], v[68:71]
    v_mfma_f32_16x16x32_bf16 v[72:75], v[152:155], v[220:223], v[72:75]
    v_mfma_f32_16x16x32_bf16 v[76:79], v[156:159], v[220:223], v[76:79]
    v_mfma_f32_16x16x32_bf16 v[80:83], v[160:163], v[220:223], v[80:83]
    v_mfma_f32_16x16x32_bf16 v[84:87], v[164:167], v[220:223], v[84:87]
    buffer_load_dwordx4 v[220:223], v7, s[68:71], s80 offen sc1
    s_waitcnt vmcnt(21)
    v_mfma_f32_16x16x32_bf16 v[8:11], v[148:151], v[208:211], v[8:11]
    v_mfma_f32_16x16x32_bf16 v[12:15], v[152:155], v[208:211], v[12:15]
    v_mfma_f32_16x16x32_bf16 v[16:19], v[156:159], v[208:211], v[16:19]
    v_mfma_f32_16x16x32_bf16 v[20:23], v[160:163], v[208:211], v[20:23]
    v_mfma_f32_16x16x32_bf16 v[24:27], v[164:167], v[208:211], v[24:27]
    buffer_load_dwordx4 v[208:211], v4, s[68:71], s80 offen sc1
    s_add_u32 s80, s80, 4096
    s_cmp_eq_u32 s80, s81
    s_cselect_b32 s80, s14, s80
    s_mov_b64 exec, 1
    ds_inc_u32 v0, v0 offset:4
    s_mov_b64 exec, -1
    s_waitcnt lgkmcnt(11)
    s_waitcnt vmcnt(21)
    v_mfma_f32_16x16x32_bf16 v[28:31], v[168:171], v[228:231], v[28:31]
    v_mfma_f32_16x16x32_bf16 v[32:35], v[172:175], v[228:231], v[32:35]
    v_mfma_f32_16x16x32_bf16 v[36:39], v[176:179], v[228:231], v[36:39]
    v_mfma_f32_16x16x32_bf16 v[40:43], v[180:183], v[228:231], v[40:43]
    v_mfma_f32_16x16x32_bf16 v[44:47], v[184:187], v[228:231], v[44:47]
    buffer_load_dwordx4 v[228:231], v5, s[68:71], s80 offen sc1
    s_waitcnt vmcnt(21)
    v_mfma_f32_16x16x32_bf16 v[48:51], v[168:171], v[232:235], v[48:51]
    v_mfma_f32_16x16x32_bf16 v[52:55], v[172:175], v[232:235], v[52:55]
    v_mfma_f32_16x16x32_bf16 v[56:59], v[176:179], v[232:235], v[56:59]
    v_mfma_f32_16x16x32_bf16 v[60:63], v[180:183], v[232:235], v[60:63]
    v_mfma_f32_16x16x32_bf16 v[64:67], v[184:187], v[232:235], v[64:67]
    buffer_load_dwordx4 v[232:235], v6, s[68:71], s80 offen sc1
    s_waitcnt vmcnt(21)
    v_mfma_f32_16x16x32_bf16 v[68:71], v[168:171], v[236:239], v[68:71]
    v_mfma_f32_16x16x32_bf16 v[72:75], v[172:175], v[236:239], v[72:75]
    v_mfma_f32_16x16x32_bf16 v[76:79], v[176:179], v[236:239], v[76:79]
    v_mfma_f32_16x16x32_bf16 v[80:83], v[180:183], v[236:239], v[80:83]
    v_mfma_f32_16x16x32_bf16 v[84:87], v[184:187], v[236:239], v[84:87]
    buffer_load_dwordx4 v[236:239], v7, s[68:71], s80 offen sc1
    s_waitcnt vmcnt(21)
    v_mfma_f32_16x16x32_bf16 v[8:11], v[168:171], v[224:227], v[8:11]
    v_mfma_f32_16x16x32_bf16 v[12:15], v[172:175], v[224:227], v[12:15]
    v_mfma_f32_16x16x32_bf16 v[16:19], v[176:179], v[224:227], v[16:19]
    v_mfma_f32_16x16x32_bf16 v[20:23], v[180:183], v[224:227], v[20:23]
    v_mfma_f32_16x16x32_bf16 v[24:27], v[184:187], v[224:227], v[24:27]
    buffer_load_dwordx4 v[224:227], v4, s[68:71], s80 offen sc1
    s_add_u32 s80, s80, 4096
    s_cmp_eq_u32 s80, s81
    s_cselect_b32 s80, s14, s80
    s_waitcnt lgkmcnt(6)
    s_waitcnt vmcnt(19)
    v_mfma_f32_16x16x32_bf16 v[28:31], v[188:191], v[244:247], v[28:31]
    v_mfma_f32_16x16x32_bf16 v[32:35], v[192:195], v[244:247], v[32:35]
    v_mfma_f32_16x16x32_bf16 v[36:39], v[196:199], v[244:247], v[36:39]
    v_mfma_f32_16x16x32_bf16 v[40:43], v[200:203], v[244:247], v[40:43]
    v_mfma_f32_16x16x32_bf16 v[44:47], v[204:207], v[244:247], v[44:47]
    buffer_load_dwordx4 v[244:247], v5, s[68:71], s80 offen sc1
    s_waitcnt vmcnt(16)
    v_mfma_f32_16x16x32_bf16 v[48:51], v[188:191], v[248:251], v[48:51]
    v_mfma_f32_16x16x32_bf16 v[52:55], v[192:195], v[248:251], v[52:55]
    v_mfma_f32_16x16x32_bf16 v[56:59], v[196:199], v[248:251], v[56:59]
    v_mfma_f32_16x16x32_bf16 v[60:63], v[200:203], v[248:251], v[60:63]
    v_mfma_f32_16x16x32_bf16 v[64:67], v[204:207], v[248:251], v[64:67]
    buffer_load_dwordx4 v[248:251], v6, s[68:71], s80 offen sc1
    s_waitcnt vmcnt(16)
    v_mfma_f32_16x16x32_bf16 v[68:71], v[188:191], v[252:255], v[68:71]
    v_mfma_f32_16x16x32_bf16 v[72:75], v[192:195], v[252:255], v[72:75]
    v_mfma_f32_16x16x32_bf16 v[76:79], v[196:199], v[252:255], v[76:79]
    v_mfma_f32_16x16x32_bf16 v[80:83], v[200:203], v[252:255], v[80:83]
    v_mfma_f32_16x16x32_bf16 v[84:87], v[204:207], v[252:255], v[84:87]
    buffer_load_dwordx4 v[252:255], v7, s[68:71], s80 offen sc1
    s_waitcnt vmcnt(16)
    v_mfma_f32_16x16x32_bf16 v[8:11], v[188:191], v[240:243], v[8:11]
    v_mfma_f32_16x16x32_bf16 v[12:15], v[192:195], v[240:243], v[12:15]
    v_mfma_f32_16x16x32_bf16 v[16:19], v[196:199], v[240:243], v[16:19]
    v_mfma_f32_16x16x32_bf16 v[20:23], v[200:203], v[240:243], v[20:23]
    v_mfma_f32_16x16x32_bf16 v[24:27], v[204:207], v[240:243], v[24:27]
    buffer_load_dwordx4 v[240:243], v4, s[68:71], s80 offen sc1
    s_add_u32 s80, s80, 4096
    s_cmp_eq_u32 s80, s81
    s_cselect_b32 s80, s14, s80
    s_waitcnt lgkmcnt(1)
    s_waitcnt vmcnt(14)
    v_mfma_f32_16x16x32_bf16 v[28:31], v[88:91], v[212:215], v[28:31]
    v_mfma_f32_16x16x32_bf16 v[32:35], v[92:95], v[212:215], v[32:35]
    v_mfma_f32_16x16x32_bf16 v[36:39], v[96:99], v[212:215], v[36:39]
    v_mfma_f32_16x16x32_bf16 v[40:43], v[100:103], v[212:215], v[40:43]
    v_mfma_f32_16x16x32_bf16 v[44:47], v[104:107], v[212:215], v[44:47]
    s_waitcnt vmcnt(10)
    v_mfma_f32_16x16x32_bf16 v[48:51], v[88:91], v[216:219], v[48:51]
    v_mfma_f32_16x16x32_bf16 v[52:55], v[92:95], v[216:219], v[52:55]
    v_mfma_f32_16x16x32_bf16 v[56:59], v[96:99], v[216:219], v[56:59]
    v_mfma_f32_16x16x32_bf16 v[60:63], v[100:103], v[216:219], v[60:63]
    v_mfma_f32_16x16x32_bf16 v[64:67], v[104:107], v[216:219], v[64:67]
    s_waitcnt vmcnt(9)
    v_mfma_f32_16x16x32_bf16 v[68:71], v[88:91], v[220:223], v[68:71]
    v_mfma_f32_16x16x32_bf16 v[72:75], v[92:95], v[220:223], v[72:75]
    v_mfma_f32_16x16x32_bf16 v[76:79], v[96:99], v[220:223], v[76:79]
    v_mfma_f32_16x16x32_bf16 v[80:83], v[100:103], v[220:223], v[80:83]
    v_mfma_f32_16x16x32_bf16 v[84:87], v[104:107], v[220:223], v[84:87]
    s_waitcnt vmcnt(8)
    v_mfma_f32_16x16x32_bf16 v[8:11], v[88:91], v[208:211], v[8:11]
    v_mfma_f32_16x16x32_bf16 v[12:15], v[92:95], v[208:211], v[12:15]
    v_mfma_f32_16x16x32_bf16 v[16:19], v[96:99], v[208:211], v[16:19]
    v_mfma_f32_16x16x32_bf16 v[20:23], v[100:103], v[208:211], v[20:23]
    v_mfma_f32_16x16x32_bf16 v[24:27], v[104:107], v[208:211], v[24:27]
    s_waitcnt vmcnt(7)
    v_mfma_f32_16x16x32_bf16 v[28:31], v[108:111], v[228:231], v[28:31]
    v_lshrrev_b32 v0, 4, v1
    v_add_u32 v148, s67, v1
    v_mfma_f32_16x16x32_bf16 v[32:35], v[112:115], v[228:231], v[32:35]
    s_sub_u32 s9, s3, 1
    s_and_b32 s9, s9, 3
    s_mul_i32 s10, s9, 10240
    v_add_u32 v2, s10, v1
    v_mfma_f32_16x16x32_bf16 v[36:39], v[116:119], v[228:231], v[36:39]
    s_sub_u32 s9, s3, 2
    s_and_b32 s9, s9, 3
    s_mul_i32 s10, s9, 10240
    v_add_u32 v3, s10, v1
    v_mfma_f32_16x16x32_bf16 v[40:43], v[120:123], v[228:231], v[40:43]
    s_sub_u32 s9, s3, 3
    s_and_b32 s9, s9, 3
    s_mul_i32 s10, s9, 10240
    v_add_u32 v4, s10, v1
    v_mfma_f32_16x16x32_bf16 v[44:47], v[124:127], v[228:231], v[44:47]
    v_lshrrev_b32 v149, 4, v0
    v_mul_u32_u24 v149, 20, v149
    s_waitcnt vmcnt(6)
    v_mfma_f32_16x16x32_bf16 v[48:51], v[108:111], v[232:235], v[48:51]
    v_bfe_u32 v150, v0, 2, 2
    v_add_u32 v150, v149, v150
    v_mfma_f32_16x16x32_bf16 v[52:55], v[112:115], v[232:235], v[52:55]
    v_and_b32 v152, 3, v0
    v_mfma_f32_16x16x32_bf16 v[56:59], v[116:119], v[232:235], v[56:59]
    s_lshl_b32 s9, s3, 5
    s_add_u32 s10, s9, 141824
    v_lshl_add_u32 v152, v152, 3, s10
    v_lshl_add_u32 v152, v150, 7, v152
    v_mfma_f32_16x16x32_bf16 v[60:63], v[120:123], v[232:235], v[60:63]
    v_and_b32 v151, 15, v0
    s_lshl_b32 s9, s9, 1
    s_add_u32 s10, s9, 134016
    v_lshl_add_u32 v6, v151, 2, s10
    v_mfma_f32_16x16x32_bf16 v[64:67], v[124:127], v[232:235], v[64:67]
    v_mul_u32_u24 v151, 1280, v151
    v_lshl_add_u32 v7, v149, 1, v151
    s_waitcnt vmcnt(5)
    v_mfma_f32_16x16x32_bf16 v[68:71], v[108:111], v[236:239], v[68:71]
    s_lshl_b32 s9, s7, 2
    s_add_u32 s9, s9, s3
    s_mul_i32 s9, s9, 20480
    s_mul_i32 s10, s8, 160
    s_add_u32 s11, s9, s10
    s_movk_i32 s10, 4608
    v_mfma_f32_16x16x32_bf16 v[72:75], v[112:115], v[236:239], v[72:75]
    v_mfma_f32_16x16x32_bf16 v[76:79], v[116:119], v[236:239], v[76:79]
    v_mfma_f32_16x16x32_bf16 v[80:83], v[120:123], v[236:239], v[80:83]
    v_mfma_f32_16x16x32_bf16 v[84:87], v[124:127], v[236:239], v[84:87]
    s_waitcnt vmcnt(4)
    v_mfma_f32_16x16x32_bf16 v[8:11], v[108:111], v[224:227], v[8:11]
    v_mfma_f32_16x16x32_bf16 v[12:15], v[112:115], v[224:227], v[12:15]
    v_mfma_f32_16x16x32_bf16 v[16:19], v[116:119], v[224:227], v[16:19]
    v_mfma_f32_16x16x32_bf16 v[20:23], v[120:123], v[224:227], v[20:23]
    v_mfma_f32_16x16x32_bf16 v[24:27], v[124:127], v[224:227], v[24:27]
    s_waitcnt vmcnt(3)
    v_mfma_f32_16x16x32_bf16 v[28:31], v[128:131], v[244:247], v[28:31]
    v_add_u32 v5, 0, v150
    v_lshrrev_b32 v5, 5, v5
    v_mad_u32_u24 v120, v5, s10, v152
    v_mfma_f32_16x16x32_bf16 v[32:35], v[132:135], v[244:247], v[32:35]
    v_add_u32 v5, 4, v150
    v_lshrrev_b32 v5, 5, v5
    v_mad_u32_u24 v121, v5, s10, v152
    v_mfma_f32_16x16x32_bf16 v[36:39], v[136:139], v[244:247], v[36:39]
    v_add_u32 v5, 8, v150
    v_lshrrev_b32 v5, 5, v5
    v_mad_u32_u24 v122, v5, s10, v152
    v_mfma_f32_16x16x32_bf16 v[40:43], v[140:143], v[244:247], v[40:43]
    v_add_u32 v5, 12, v150
    v_lshrrev_b32 v5, 5, v5
    v_mad_u32_u24 v123, v5, s10, v152
    v_mfma_f32_16x16x32_bf16 v[44:47], v[144:147], v[244:247], v[44:47]
    v_add_u32 v5, 16, v150
    v_lshrrev_b32 v5, 5, v5
    v_mad_u32_u24 v124, v5, s10, v152
    s_waitcnt vmcnt(2)
    v_mfma_f32_16x16x32_bf16 v[48:51], v[128:131], v[248:251], v[48:51]
    ds_write_b128 v148, v[28:31] offset:0
    v_mfma_f32_16x16x32_bf16 v[52:55], v[132:135], v[248:251], v[52:55]
    ds_write_b128 v148, v[32:35] offset:1024
    v_mfma_f32_16x16x32_bf16 v[56:59], v[136:139], v[248:251], v[56:59]
    ds_write_b128 v148, v[36:39] offset:2048
    v_mfma_f32_16x16x32_bf16 v[60:63], v[140:143], v[248:251], v[60:63]
    ds_write_b128 v148, v[40:43] offset:3072
    v_mfma_f32_16x16x32_bf16 v[64:67], v[144:147], v[248:251], v[64:67]
    ds_write_b128 v148, v[44:47] offset:4096
    s_waitcnt vmcnt(1)
    v_mfma_f32_16x16x32_bf16 v[68:71], v[128:131], v[252:255], v[68:71]
    ds_write_b128 v148, v[48:51] offset:5120
    v_mfma_f32_16x16x32_bf16 v[72:75], v[132:135], v[252:255], v[72:75]
    ds_write_b128 v148, v[52:55] offset:6144
    v_mfma_f32_16x16x32_bf16 v[76:79], v[136:139], v[252:255], v[76:79]
    ds_write_b128 v148, v[56:59] offset:7168
    v_mfma_f32_16x16x32_bf16 v[80:83], v[140:143], v[252:255], v[80:83]
    ds_write_b128 v148, v[60:63] offset:8192
    v_mfma_f32_16x16x32_bf16 v[84:87], v[144:147], v[252:255], v[84:87]
    ds_write_b128 v148, v[64:67] offset:9216
    s_waitcnt vmcnt(0)
    v_mfma_f32_16x16x32_bf16 v[8:11], v[128:131], v[240:243], v[8:11]
    ds_write_b128 v148, v[68:71] offset:40992
    v_mfma_f32_16x16x32_bf16 v[12:15], v[132:135], v[240:243], v[12:15]
    ds_write_b128 v148, v[72:75] offset:42016
    v_mfma_f32_16x16x32_bf16 v[16:19], v[136:139], v[240:243], v[16:19]
    ds_write_b128 v148, v[76:79] offset:43040
    v_mfma_f32_16x16x32_bf16 v[20:23], v[140:143], v[240:243], v[20:23]
    ds_write_b128 v148, v[80:83] offset:44064
    v_mfma_f32_16x16x32_bf16 v[24:27], v[144:147], v[240:243], v[24:27]
    ds_write_b128 v148, v[84:87] offset:45088
    s_waitcnt lgkmcnt(0)
    s_barrier
    ds_read_b32 v98, v6
    ds_read_b64_tr_b16 v[88:89], v120 offset:0
    ds_read_b128 v[192:195], v2 offset:0
    ds_read_b128 v[196:199], v3 offset:5120
    ds_read_b128 v[200:203], v4 offset:40992
    ds_read_b64_tr_b16 v[90:91], v121 offset:512
    ds_read_b128 v[204:207], v2 offset:1024
    ds_read_b128 v[208:211], v3 offset:6144
    ds_read_b128 v[212:215], v4 offset:42016
    ds_read_b64_tr_b16 v[92:93], v122 offset:1024
    ds_read_b128 v[216:219], v2 offset:2048
    ds_read_b128 v[220:223], v3 offset:7168
    ds_read_b128 v[224:227], v4 offset:43040
    s_waitcnt lgkmcnt(8)
    v_add_f32 v8, v8, v192
    v_add_f32 v196, v196, v200
    v_add_f32 v9, v9, v193
    v_add_f32 v197, v197, v201
    v_add_f32 v10, v10, v194
    v_add_f32 v198, v198, v202
    v_add_f32 v11, v11, v195
    v_add_f32 v199, v199, v203
    v_lshlrev_b32 v100, 16, v88
    v_add_f32 v8, v8, v196
    v_and_b32 v101, 0xffff0000, v88
    v_add_f32 v9, v9, v197
    v_lshlrev_b32 v102, 16, v89
    v_add_f32 v10, v10, v198
    v_and_b32 v103, 0xffff0000, v89
    v_add_f32 v11, v11, v199
    v_sub_f32 v100, v100, v8
    v_sub_f32 v101, v101, v9
    v_sub_f32 v102, v102, v10
    v_sub_f32 v103, v103, v11
    v_fmac_f32 v8, v98, v100
    v_fmac_f32 v9, v98, v101
    v_fmac_f32 v10, v98, v102
    v_fmac_f32 v11, v98, v103
    v_cvt_pk_bf16_f32 v108, v8, v9
    v_cvt_pk_bf16_f32 v109, v10, v11
    ds_read_b64_tr_b16 v[94:95], v123 offset:1536
    ds_read_b128 v[228:231], v2 offset:3072
    ds_read_b128 v[232:235], v3 offset:8192
    ds_read_b128 v[236:239], v4 offset:44064
    s_waitcnt lgkmcnt(8)
    v_add_f32 v12, v12, v204
    v_add_f32 v208, v208, v212
    v_add_f32 v13, v13, v205
    v_add_f32 v209, v209, v213
    v_add_f32 v14, v14, v206
    v_add_f32 v210, v210, v214
    v_add_f32 v15, v15, v207
    v_add_f32 v211, v211, v215
    v_lshlrev_b32 v100, 16, v90
    v_add_f32 v12, v12, v208
    v_and_b32 v101, 0xffff0000, v90
    v_add_f32 v13, v13, v209
    v_lshlrev_b32 v102, 16, v91
    v_add_f32 v14, v14, v210
    v_and_b32 v103, 0xffff0000, v91
    v_add_f32 v15, v15, v211
    v_sub_f32 v100, v100, v12
    v_sub_f32 v101, v101, v13
    v_sub_f32 v102, v102, v14
    v_sub_f32 v103, v103, v15
    v_fmac_f32 v12, v98, v100
    v_fmac_f32 v13, v98, v101
    v_fmac_f32 v14, v98, v102
    v_fmac_f32 v15, v98, v103
    v_cvt_pk_bf16_f32 v110, v12, v13
    v_cvt_pk_bf16_f32 v111, v14, v15
    buffer_store_dwordx4 v[108:111], v7, s[72:75], s11 offen offset:0
    ds_read_b64_tr_b16 v[96:97], v124 offset:2048
    ds_read_b128 v[240:243], v2 offset:4096
    ds_read_b128 v[244:247], v3 offset:9216
    ds_read_b128 v[248:251], v4 offset:45088
    s_waitcnt lgkmcnt(8)
    v_add_f32 v16, v16, v216
    v_add_f32 v220, v220, v224
    v_add_f32 v17, v17, v217
    v_add_f32 v221, v221, v225
    v_add_f32 v18, v18, v218
    v_add_f32 v222, v222, v226
    v_add_f32 v19, v19, v219
    v_add_f32 v223, v223, v227
    v_lshlrev_b32 v100, 16, v92
    v_add_f32 v16, v16, v220
    v_and_b32 v101, 0xffff0000, v92
    v_add_f32 v17, v17, v221
    v_lshlrev_b32 v102, 16, v93
    v_add_f32 v18, v18, v222
    v_and_b32 v103, 0xffff0000, v93
    v_add_f32 v19, v19, v223
    v_sub_f32 v100, v100, v16
    v_sub_f32 v101, v101, v17
    v_sub_f32 v102, v102, v18
    v_sub_f32 v103, v103, v19
    v_fmac_f32 v16, v98, v100
    v_fmac_f32 v17, v98, v101
    v_fmac_f32 v18, v98, v102
    v_fmac_f32 v19, v98, v103
    v_cvt_pk_bf16_f32 v112, v16, v17
    v_cvt_pk_bf16_f32 v113, v18, v19
    s_waitcnt lgkmcnt(4)
    v_add_f32 v20, v20, v228
    v_add_f32 v232, v232, v236
    v_add_f32 v21, v21, v229
    v_add_f32 v233, v233, v237
    v_add_f32 v22, v22, v230
    v_add_f32 v234, v234, v238
    v_add_f32 v23, v23, v231
    v_add_f32 v235, v235, v239
    v_lshlrev_b32 v100, 16, v94
    v_add_f32 v20, v20, v232
    v_and_b32 v101, 0xffff0000, v94
    v_add_f32 v21, v21, v233
    v_lshlrev_b32 v102, 16, v95
    v_add_f32 v22, v22, v234
    v_and_b32 v103, 0xffff0000, v95
    v_add_f32 v23, v23, v235
    v_sub_f32 v100, v100, v20
    v_sub_f32 v101, v101, v21
    v_sub_f32 v102, v102, v22
    v_sub_f32 v103, v103, v23
    v_fmac_f32 v20, v98, v100
    v_fmac_f32 v21, v98, v101
    v_fmac_f32 v22, v98, v102
    v_fmac_f32 v23, v98, v103
    v_cvt_pk_bf16_f32 v114, v20, v21
    v_cvt_pk_bf16_f32 v115, v22, v23
    buffer_store_dwordx4 v[112:115], v7, s[72:75], s11 offen offset:16
    s_waitcnt lgkmcnt(0)
    v_add_f32 v24, v24, v240
    v_add_f32 v244, v244, v248
    v_add_f32 v25, v25, v241
    v_add_f32 v245, v245, v249
    v_add_f32 v26, v26, v242
    v_add_f32 v246, v246, v250
    v_add_f32 v27, v27, v243
    v_add_f32 v247, v247, v251
    v_lshlrev_b32 v100, 16, v96
    v_add_f32 v24, v24, v244
    v_and_b32 v101, 0xffff0000, v96
    v_add_f32 v25, v25, v245
    v_lshlrev_b32 v102, 16, v97
    v_add_f32 v26, v26, v246
    v_and_b32 v103, 0xffff0000, v97
    v_add_f32 v27, v27, v247
    v_sub_f32 v100, v100, v24
    v_sub_f32 v101, v101, v25
    v_sub_f32 v102, v102, v26
    v_sub_f32 v103, v103, v27
    v_fmac_f32 v24, v98, v100
    v_fmac_f32 v25, v98, v101
    v_fmac_f32 v26, v98, v102
    v_fmac_f32 v27, v98, v103
    v_cvt_pk_bf16_f32 v116, v24, v25
    v_cvt_pk_bf16_f32 v117, v26, v27
    buffer_store_dwordx2 v[116:117], v7, s[72:75], s11 offen offset:32
    s_endpgm
END:
    s_endpgm
.section .rodata,"a"
.p2align 6
.amdhsa_kernel gated_mix__ssm_conv_s4__glu_gated_bilinear__prompt_kernel
  .amdhsa_next_free_vgpr 256
  .amdhsa_next_free_sgpr 102
  .amdhsa_accum_offset 256
  .amdhsa_group_segment_fixed_size 0
  .amdhsa_kernarg_size 136
  .amdhsa_user_sgpr_count 2
  .amdhsa_user_sgpr_kernarg_segment_ptr 1
  .amdhsa_system_sgpr_workgroup_id_x 1
.end_amdhsa_kernel
```
